```python
import torch

def _softmax(x, axis=-1):
    return torch.softmax(x, dim=axis)
def _gelu(x):
    return torch.nn.functional.gelu(x, approximate="tanh")
def _silu(x):
    return torch.nn.functional.silu(x)
def _sigmoid(x):
    return torch.sigmoid(x)
def _layernorm(x, axis=-1, eps=1e-5):
    m = x.mean(dim=axis, keepdim=True)
    v = x.var(dim=axis, keepdim=True, unbiased=False)
    return (x - m) / torch.sqrt(v + eps)
def _scatter_add(tgt, idx, src, axis=0):
    return tgt.clone().index_add_(axis, idx, src)
def _segment_sum(src, seg, n):
    out = torch.zeros((n,) + src.shape[1:], dtype=src.dtype)
    return out.index_add_(0, seg, src)
def _pad(x, pw):
    flat = tuple(v for pair in reversed(pw) for v in pair)
    return torch.nn.functional.pad(x, flat)

kernel_name = 'standalone__gqa_block_cached__near_ridge'

def setup_inputs():

    _w = (lambda a: (lambda t: t.to(torch.bfloat16) if t.is_floating_point() else t)(torch.as_tensor(a)))
    B, Sq, D = 8, 32, 1024
    Hq, Hkv, Sk, Dh = 32, 4, 1024, 128
    assert Hq % Hkv == 0, (Hq, Hkv)
    return {
        "x": _w((lambda *s: torch.randn(*s, dtype=torch.bfloat16) * 0.8)(B, Sq, D)),
        "k_cache": _w((lambda *s: torch.randn(*s, dtype=torch.bfloat16) * 0.8)(B, Hkv, Sk, Dh)),
        "v_cache": _w((lambda *s: torch.randn(*s, dtype=torch.bfloat16) * 0.05)(B, Hkv, Sk, Dh)),
        "wq": _w((lambda *s: torch.randn(*s, dtype=torch.bfloat16) * 0.8)(D, Hq * Dh) * (D ** -0.5)),
        "wo": _w((lambda *s: torch.randn(*s, dtype=torch.bfloat16) * 0.05)(Hq * Dh, D) * ((Hq * Dh) ** -0.5)),
    }

def reference(x, k_cache, v_cache, wq, wo):
    B, Sq, D = x.shape
    Hq, Dh = 32, 128
    Hkv = k_cache.shape[1]
    rep = Hq // Hkv
    q = (lambda x, *d: x.permute(*d))((x @ wq).reshape(B, Sq, Hq, Dh), 0, 2, 1, 3)
    k = (lambda x, n, axis: torch.repeat_interleave(x, n, dim=axis))(k_cache, rep, axis=1)
    v = (lambda x, n, axis: torch.repeat_interleave(x, n, dim=axis))(v_cache, rep, axis=1)
    scores = torch.einsum("bhqd,bhkd->bhqk", q, k) * (Dh ** -0.5)
    p = _softmax(scores, axis=-1)
    o = torch.einsum("bhqk,bhkd->bhqd", p, v)
    return (lambda x, *d: x.permute(*d))(o, 0, 2, 1, 3).reshape(B, Sq, Hq * Dh) @ wo
```

```asm
; @launch grid=(256,1,1) block=(256,1,1) lds=163840
.amdgcn_target "amdgcn-amd-amdhsa--gfx950"
.text
.globl standalone__gqa_block_cached__near_ridge_kernel
.p2align 8
.type standalone__gqa_block_cached__near_ridge_kernel,@function
standalone__gqa_block_cached__near_ridge_kernel:
  s_cmp_lt_u32 s2, 256
  s_cbranch_scc1 L_go
  s_endpgm
L_go:
  s_load_dwordx2 s[32:33], s[0:1], 24
  s_load_dwordx2 s[20:21], s[0:1], 0
  s_load_dwordx2 s[44:45], s[0:1], 56
  s_load_dwordx2 s[24:25], s[0:1], 8
  s_load_dwordx2 s[28:29], s[0:1], 16
  s_load_dwordx2 s[36:37], s[0:1], 32
  s_load_dwordx2 s[40:41], s[0:1], 40
  s_getpc_b64 s[6:7]
L_pc:
  s_lshr_b32 s67, s2, 3
  s_lshl_b32 s67, s67, 10
  v_lshrrev_b32 v4, 5, v0
  v_lshlrev_b32 v4, 7, v4
  v_add_u32 v4, s67, v4
  v_min_u32 v4, L_end-L_pc-4, v4
  global_load_dword v255, v4, s[6:7]
  v_lshrrev_b32 v5, 6, v0
  v_and_b32 v0, 63, v0
  v_readfirstlane_b32 s48, v5
  s_mov_b32 s34, 8388608
  s_mov_b32 s35, 0x20000
  s_mov_b32 s22, 524288
  s_mov_b32 s23, 0x20000
  s_and_b32 s49, s2, 7
  s_lshr_b32 s50, s2, 3
  s_lshr_b32 s52, s50, 3
  s_and_b32 s8, s50, 7
  s_lshl_b32 s53, s49, 3
  s_add_u32 s53, s53, s8
  s_lshr_b32 s8, s8, 1
  s_add_u32 s8, s8, s52
  s_and_b32 s8, s8, 3
  s_lshl_b32 s62, s52, 17
  s_lshl_b32 s67, s48, 15
  s_or_b32 s62, s62, s67
  s_lshl_b32 s67, s8, 9
  s_or_b32 s62, s62, s67
  s_lshl_b32 s63, s48, 17
  s_lshl_b32 s67, s8, 21
  s_or_b32 s63, s63, s67
  s_lshl_b32 s67, s53, 7
  s_or_b32 s63, s63, s67
  s_lshl_b32 s17, s48, 11
  s_lshl_b32 s16, s48, 12
  v_lshrrev_b32 v4, 3, v0
  v_and_b32 v5, 7, v0
  v_lshrrev_b32 v6, 1, v4
  v_xor_b32 v2, v5, v6
  v_lshlrev_b32 v2, 4, v2
  v_lshl_add_u32 v8, v4, 11, v2
  v_xor_b32 v9, 64, v8
  v_add_u32 v9, 15360, v9
  v_and_b32 v6, 1, v6
  v_lshlrev_b32 v6, 2, v6
  v_xor_b32 v2, v5, v6
  v_lshlrev_b32 v2, 4, v2
  v_lshl_add_u32 v10, v4, 13, v2
  v_add_u32 v11, 64512, v10
  s_waitcnt lgkmcnt(0)
  s_add_u32 m0, s17, 8192
  s_xor_b32 s11, s63, 0
  buffer_load_dwordx4 v10, s[32:35], s11 offen  lds
  buffer_load_dwordx4 v11, s[32:35], s11 offen offset:1024  lds
  s_add_u32 m0, s17, 0
  s_xor_b32 s11, s62, 0
  buffer_load_dwordx4 v8, s[20:23], s11 offen  lds
  buffer_load_dwordx4 v9, s[20:23], s11 offen offset:1024  lds
  s_mov_b32 s46, 268435456
  s_mov_b32 s47, 0x20000
  s_mov_b32 s26, 8388608
  s_mov_b32 s27, 0x20000
  s_mov_b32 s30, 8388608
  s_mov_b32 s31, 0x20000
  s_mov_b32 s38, 8388608
  s_mov_b32 s39, 0x20000
  s_mov_b32 s42, 524288
  s_mov_b32 s43, 0x20000
  v_and_b32 v4, 31, v0
  v_lshrrev_b32 v5, 5, v0
  s_add_u32 m0, s17, 24576
  s_xor_b32 s11, s63, 524288
  buffer_load_dwordx4 v10, s[32:35], s11 offen  lds
  v_bfe_u32 v6, v0, 1, 3
  v_xor_b32 v6, v5, v6
  v_lshlrev_b32 v6, 4, v6
  v_lshl_add_u32 v6, v4, 7, v6
  s_lshr_b32 s67, s48, 1
  s_lshl_b32 s67, s67, 12
  v_add_u32 v29, s67, v6
  v_xor_b32 v30, 32, v29
  v_xor_b32 v31, 64, v29
  v_xor_b32 v32, 96, v29
  v_bfe_u32 v4, v0, 2, 2
  v_lshl_add_u32 v5, v5, 3, v4
  buffer_load_dwordx4 v11, s[32:35], s11 offen offset:1024  lds
  v_lshlrev_b32 v5, 7, v5
  v_lshrrev_b32 v4, 1, v4
  s_and_b32 s67, s48, 1
  v_xor_b32 v4, s67, v4
  v_lshl_add_u32 v5, v4, 6, v5
  v_bfe_u32 v4, v0, 4, 1
  v_lshl_add_u32 v5, v4, 5, v5
  v_and_b32 v4, 1, v0
  v_lshl_add_u32 v5, v4, 4, v5
  v_bfe_u32 v4, v0, 1, 1
  v_lshl_add_u32 v5, v4, 3, v5
  v_add_u32 v7, 8192, v5
  s_add_u32 m0, s17, 16384
  s_xor_b32 s11, s62, 128
  buffer_load_dwordx4 v8, s[20:23], s11 offen  lds
  v_lshlrev_b32 v1, 4, v0
  s_and_b32 s51, s49, 3
  s_and_b32 s54, s49, 4
  s_add_u32 s54, s54, s52
  s_bfe_u32 s55, s50, 0x20001
  s_and_b32 s56, s50, 1
  s_lshr_b32 s57, s48, 1
  s_and_b32 s58, s48, 1
  s_lshr_b32 s59, s50, 2
  s_and_b32 s60, s49, 4
  s_and_b32 s67, s50, 3
  s_add_u32 s60, s60, s67
  buffer_load_dwordx4 v9, s[20:23], s11 offen offset:1024  lds
  s_lshl_b32 s61, s54, 2
  s_add_u32 s61, s61, s51
  s_and_b32 s60, s49, 4
  s_lshl_b32 s60, s60, 1
  s_and_b32 s67, s50, 7
  s_add_u32 s60, s60, s67
  s_add_u32 s4, s44, 10813440
  s_addc_u32 s5, s45, 0
  s_lshl_b32 s67, s52, 9
  s_load_dword s15, s[4:5], s67
  s_add_u32 s9, s67, 256
  s_load_dword s59, s[4:5], s9
  s_add_u32 m0, s17, 40960
  s_xor_b32 s11, s63, 1048576
  buffer_load_dwordx4 v10, s[32:35], s11 offen  lds
  s_lshl_b32 s8, s54, 8
  s_load_dword s14, s[4:5], s8
  s_lshl_b32 s64, s61, 18
  s_lshl_b32 s67, s56, 17
  s_or_b32 s64, s64, s67
  s_lshl_b32 s67, s57, 16
  s_or_b32 s64, s64, s67
  s_and_b32 s67, s55, 3
  s_lshl_b32 s67, s67, 14
  s_or_b32 s64, s64, s67
  s_lshl_b32 s67, s58, 12
  s_or_b32 s64, s64, s67
  buffer_load_dwordx4 v11, s[32:35], s11 offen offset:1024  lds
  s_and_b32 s18, s50, 6
  s_lshl_b32 s67, s52, 1
  s_add_u32 s18, s18, s67
  s_and_b32 s18, s18, 7
  s_lshl_b32 s65, s51, 21
  s_lshl_b32 s67, s48, 19
  s_or_b32 s65, s65, s67
  s_lshl_b32 s67, s18, 16
  s_or_b32 s65, s65, s67
  s_lshl_b32 s67, s60, 7
  s_or_b32 s65, s65, s67
  s_lshl_b32 s66, s52, 3
  s_add_u32 s66, s66, s51
  s_add_u32 m0, s17, 32768
  s_xor_b32 s11, s62, 256
  buffer_load_dwordx4 v8, s[20:23], s11 offen  lds
  s_lshl_b32 s66, s66, 16
  s_lshl_b32 s67, s48, 14
  s_or_b32 s66, s66, s67
  s_lshl_b32 s67, s18, 11
  s_or_b32 s66, s66, s67
  s_add_u32 s66, s66, 2097152
  s_mov_b32 s10, 0x3e0293ee
  v_lshrrev_b32 v4, 4, v0
  v_and_b32 v5, 15, v0
  v_lshlrev_b32 v6, 2, v4
  v_xor_b32 v6, v6, v5
  v_lshlrev_b32 v6, 4, v6
  buffer_load_dwordx4 v9, s[20:23], s11 offen offset:1024  lds
  v_lshl_add_u32 v16, v4, 8, v6
  v_lshl_add_u32 v17, v4, 11, v6
  v_lshrrev_b32 v2, 3, v0
  v_bfe_u32 v39, v0, 4, 1
  v_lshlrev_b32 v39, 2, v39
  v_and_b32 v17, 7, v0
  v_xor_b32 v17, v17, v39
  v_lshlrev_b32 v17, 4, v17
  v_lshl_add_u32 v17, v2, 11, v17
  v_add_u32 v18, 15360, v17
  v_add_u32 v19, 30720, v17
  v_add_u32 v20, 46080, v17
  s_add_u32 m0, s17, 57344
  s_xor_b32 s11, s63, 1572864
  buffer_load_dwordx4 v10, s[32:35], s11 offen  lds
  v_xor_b32 v6, v4, v5
  v_lshlrev_b32 v6, 4, v6
  v_lshl_add_u32 v12, v4, 8, v6
  v_xor_b32 v13, 64, v12
  v_xor_b32 v14, 128, v12
  v_xor_b32 v15, 192, v12
  v_and_b32 v4, 31, v0
  v_lshrrev_b32 v6, 5, v0
  v_xor_b32 v6, v6, v5
  v_lshlrev_b32 v6, 4, v6
  v_lshl_add_u32 v6, v4, 8, v6
  s_lshl_b32 s67, s57, 13
  buffer_load_dwordx4 v11, s[32:35], s11 offen offset:1024  lds
  v_add_u32 v21, s67, v6
  v_xor_b32 v22, 32, v21
  v_xor_b32 v23, 64, v21
  v_xor_b32 v24, 96, v21
  v_xor_b32 v25, 128, v21
  v_xor_b32 v26, 160, v21
  v_xor_b32 v27, 192, v21
  v_xor_b32 v28, 224, v21
  v_bfe_u32 v4, v0, 2, 2
  v_lshrrev_b32 v5, 5, v0
  v_lshl_add_u32 v5, v5, 2, v4
  v_lshlrev_b32 v5, 8, v5
  s_add_u32 m0, s17, 49152
  s_xor_b32 s11, s62, 384
  buffer_load_dwordx4 v8, s[20:23], s11 offen  lds
  v_and_b32 v6, 3, v0
  v_lshl_add_u32 v5, v6, 3, v5
  v_bfe_u32 v6, v0, 4, 1
  v_lshl_add_u32 v5, v6, 5, v5
  v_lshl_add_u32 v39, v4, 6, v5
  s_lshl_b32 s8, s57, 1
  s_add_u32 s8, s8, 1
  s_sub_u32 s8, s8, s56
  v_xor_b32 v4, s8, v4
  v_lshl_add_u32 v5, v4, 6, v5
  v_add_u32 v33, s67, v5
  v_xor_b32 v34, 64, v33
  buffer_load_dwordx4 v9, s[20:23], s11 offen offset:1024  lds
  v_xor_b32 v35, 128, v33
  v_xor_b32 v36, 192, v33
  v_bfe_u32 v4, v0, 2, 2
  v_lshrrev_b32 v5, 5, v0
  v_lshl_add_u32 v5, v5, 2, v4
  v_lshlrev_b32 v5, 7, v5
  v_lshrrev_b32 v4, 1, v4
  v_lshl_add_u32 v5, v4, 6, v5
  v_and_b32 v4, 3, v0
  v_lshl_add_u32 v5, v4, 3, v5
  v_bfe_u32 v4, v0, 4, 1
  v_lshl_add_u32 v39, v4, 5, v5
  v_add_u32 v3, s16, v39
  s_waitcnt lgkmcnt(0)
  s_mul_i32 s15, s15, 2654435761
  s_add_u32 s15, s15, 2135587861
  s_mul_i32 s59, s59, 2654435761
  s_add_u32 s59, s59, 2135587861
  s_mul_i32 s14, s14, 2654435761
  s_add_u32 s14, s14, 2135587861
  s_cmp_eq_u32 s57, 0
  s_cselect_b32 s13, s15, s59
  s_waitcnt vmcnt(12)
  s_barrier
  ds_read_b128 v[144:147], v29 offset:0
  ds_read_b64_tr_b16 v[128:129], v7 offset:0
  ds_read_b64_tr_b16 v[130:131], v7 offset:512
  ds_read_b128 v[148:151], v30 offset:0
  ds_read_b64_tr_b16 v[132:133], v7 offset:2048
  ds_read_b64_tr_b16 v[134:135], v7 offset:2560
  ds_read_b128 v[152:155], v31 offset:0
  ds_read_b64_tr_b16 v[136:137], v7 offset:4096
  ds_read_b64_tr_b16 v[138:139], v7 offset:4608
  ds_read_b128 v[156:159], v32 offset:0
  ds_read_b64_tr_b16 v[140:141], v7 offset:6144
  ds_read_b64_tr_b16 v[142:143], v7 offset:6656
  s_add_u32 m0, s17, 73728
  s_xor_b32 s11, s63, 2097152
  buffer_load_dwordx4 v10, s[32:35], s11 offen  lds
  buffer_load_dwordx4 v11, s[32:35], s11 offen offset:1024  lds
  s_add_u32 m0, s17, 65536
  s_xor_b32 s11, s62, 512
  buffer_load_dwordx4 v8, s[20:23], s11 offen  lds
  buffer_load_dwordx4 v9, s[20:23], s11 offen offset:1024  lds
  s_waitcnt vmcnt(12)
  s_barrier
  ds_read_b128 v[176:179], v29 offset:16384
  ds_read_b64_tr_b16 v[160:161], v7 offset:16384
  ds_read_b64_tr_b16 v[162:163], v7 offset:16896
  ds_read_b128 v[180:183], v30 offset:16384
  ds_read_b64_tr_b16 v[164:165], v7 offset:18432
  ds_read_b64_tr_b16 v[166:167], v7 offset:18944
  ds_read_b128 v[184:187], v31 offset:16384
  ds_read_b64_tr_b16 v[168:169], v7 offset:20480
  ds_read_b64_tr_b16 v[170:171], v7 offset:20992
  ds_read_b128 v[188:191], v32 offset:16384
  ds_read_b64_tr_b16 v[172:173], v7 offset:22528
  ds_read_b64_tr_b16 v[174:175], v7 offset:23040
  s_waitcnt lgkmcnt(15)
  v_mfma_f32_32x32x16_bf16 v[64:79], v[128:131], v[144:147], 0
  s_add_u32 m0, s17, 90112
  s_xor_b32 s11, s63, 2621440
  buffer_load_dwordx4 v10, s[32:35], s11 offen  lds
  v_mfma_f32_32x32x16_bf16 v[64:79], v[132:135], v[148:151], v[64:79]
  buffer_load_dwordx4 v11, s[32:35], s11 offen offset:1024  lds
  v_mfma_f32_32x32x16_bf16 v[64:79], v[136:139], v[152:155], v[64:79]
  s_add_u32 m0, s17, 81920
  s_xor_b32 s11, s62, 640
  buffer_load_dwordx4 v8, s[20:23], s11 offen  lds
  s_waitcnt lgkmcnt(12)
  v_mfma_f32_32x32x16_bf16 v[64:79], v[140:143], v[156:159], v[64:79]
  buffer_load_dwordx4 v9, s[20:23], s11 offen offset:1024  lds
  s_waitcnt vmcnt(12)
  s_barrier
  ds_read_b128 v[144:147], v29 offset:32768
  ds_read_b64_tr_b16 v[128:129], v7 offset:32768
  ds_read_b64_tr_b16 v[130:131], v7 offset:33280
  ds_read_b128 v[148:151], v30 offset:32768
  ds_read_b64_tr_b16 v[132:133], v7 offset:34816
  ds_read_b64_tr_b16 v[134:135], v7 offset:35328
  ds_read_b128 v[152:155], v31 offset:32768
  ds_read_b64_tr_b16 v[136:137], v7 offset:36864
  ds_read_b64_tr_b16 v[138:139], v7 offset:37376
  ds_read_b128 v[156:159], v32 offset:32768
  ds_read_b64_tr_b16 v[140:141], v7 offset:38912
  ds_read_b64_tr_b16 v[142:143], v7 offset:39424
  s_waitcnt lgkmcnt(15)
  v_mfma_f32_32x32x16_bf16 v[64:79], v[160:163], v[176:179], v[64:79]
  s_add_u32 m0, s17, 106496
  s_xor_b32 s11, s63, 3145728
  buffer_load_dwordx4 v10, s[32:35], s11 offen  lds
  v_mfma_f32_32x32x16_bf16 v[64:79], v[164:167], v[180:183], v[64:79]
  buffer_load_dwordx4 v11, s[32:35], s11 offen offset:1024  lds
  v_mfma_f32_32x32x16_bf16 v[64:79], v[168:171], v[184:187], v[64:79]
  s_add_u32 m0, s17, 98304
  s_xor_b32 s11, s62, 768
  buffer_load_dwordx4 v8, s[20:23], s11 offen  lds
  s_waitcnt lgkmcnt(12)
  v_mfma_f32_32x32x16_bf16 v[64:79], v[172:175], v[188:191], v[64:79]
  buffer_load_dwordx4 v9, s[20:23], s11 offen offset:1024  lds
  s_waitcnt vmcnt(12)
  s_barrier
  ds_read_b128 v[176:179], v29 offset:49152
  ds_read_b64_tr_b16 v[160:161], v7 offset:49152
  ds_read_b64_tr_b16 v[162:163], v7 offset:49664
  ds_read_b128 v[180:183], v30 offset:49152
  ds_read_b64_tr_b16 v[164:165], v7 offset:51200
  ds_read_b64_tr_b16 v[166:167], v7 offset:51712
  ds_read_b128 v[184:187], v31 offset:49152
  ds_read_b64_tr_b16 v[168:169], v7 offset:53248
  ds_read_b64_tr_b16 v[170:171], v7 offset:53760
  ds_read_b128 v[188:191], v32 offset:49152
  ds_read_b64_tr_b16 v[172:173], v7 offset:55296
  ds_read_b64_tr_b16 v[174:175], v7 offset:55808
  s_waitcnt lgkmcnt(15)
  v_mfma_f32_32x32x16_bf16 v[64:79], v[128:131], v[144:147], v[64:79]
  s_add_u32 m0, s17, 122880
  s_xor_b32 s11, s63, 3670016
  buffer_load_dwordx4 v10, s[32:35], s11 offen  lds
  v_mfma_f32_32x32x16_bf16 v[64:79], v[132:135], v[148:151], v[64:79]
  buffer_load_dwordx4 v11, s[32:35], s11 offen offset:1024  lds
  v_mfma_f32_32x32x16_bf16 v[64:79], v[136:139], v[152:155], v[64:79]
  s_add_u32 m0, s17, 114688
  s_xor_b32 s11, s62, 896
  buffer_load_dwordx4 v8, s[20:23], s11 offen  lds
  s_waitcnt lgkmcnt(12)
  v_mfma_f32_32x32x16_bf16 v[64:79], v[140:143], v[156:159], v[64:79]
  buffer_load_dwordx4 v9, s[20:23], s11 offen offset:1024  lds
  s_waitcnt vmcnt(12)
  s_barrier
  v_add_u32 v29, 0x10000, v29
  v_add_u32 v30, 0x10000, v30
  v_add_u32 v31, 0x10000, v31
  v_add_u32 v32, 0x10000, v32
  v_add_u32 v7, 0x10000, v7
  ds_read_b128 v[144:147], v29 offset:0
  ds_read_b64_tr_b16 v[128:129], v7 offset:0
  ds_read_b64_tr_b16 v[130:131], v7 offset:512
  ds_read_b128 v[148:151], v30 offset:0
  ds_read_b64_tr_b16 v[132:133], v7 offset:2048
  ds_read_b64_tr_b16 v[134:135], v7 offset:2560
  ds_read_b128 v[152:155], v31 offset:0
  ds_read_b64_tr_b16 v[136:137], v7 offset:4096
  ds_read_b64_tr_b16 v[138:139], v7 offset:4608
  ds_read_b128 v[156:159], v32 offset:0
  ds_read_b64_tr_b16 v[140:141], v7 offset:6144
  ds_read_b64_tr_b16 v[142:143], v7 offset:6656
  s_waitcnt lgkmcnt(15)
  v_mfma_f32_32x32x16_bf16 v[64:79], v[160:163], v[176:179], v[64:79]
  s_add_u32 m0, s17, 139264
  s_xor_b32 s11, s63, 4194304
  buffer_load_dwordx4 v10, s[32:35], s11 offen  lds
  v_mfma_f32_32x32x16_bf16 v[64:79], v[164:167], v[180:183], v[64:79]
  buffer_load_dwordx4 v11, s[32:35], s11 offen offset:1024  lds
  v_mfma_f32_32x32x16_bf16 v[64:79], v[168:171], v[184:187], v[64:79]
  s_add_u32 m0, s17, 131072
  s_xor_b32 s11, s62, 1024
  buffer_load_dwordx4 v8, s[20:23], s11 offen  lds
  s_waitcnt lgkmcnt(12)
  v_mfma_f32_32x32x16_bf16 v[64:79], v[172:175], v[188:191], v[64:79]
  buffer_load_dwordx4 v9, s[20:23], s11 offen offset:1024  lds
  s_waitcnt vmcnt(12)
  s_barrier
  ds_read_b128 v[176:179], v29 offset:16384
  ds_read_b64_tr_b16 v[160:161], v7 offset:16384
  ds_read_b64_tr_b16 v[162:163], v7 offset:16896
  ds_read_b128 v[180:183], v30 offset:16384
  ds_read_b64_tr_b16 v[164:165], v7 offset:18432
  ds_read_b64_tr_b16 v[166:167], v7 offset:18944
  ds_read_b128 v[184:187], v31 offset:16384
  ds_read_b64_tr_b16 v[168:169], v7 offset:20480
  ds_read_b64_tr_b16 v[170:171], v7 offset:20992
  ds_read_b128 v[188:191], v32 offset:16384
  ds_read_b64_tr_b16 v[172:173], v7 offset:22528
  ds_read_b64_tr_b16 v[174:175], v7 offset:23040
  s_waitcnt lgkmcnt(15)
  v_mfma_f32_32x32x16_bf16 v[64:79], v[128:131], v[144:147], v[64:79]
  s_add_u32 m0, s17, 8192
  s_xor_b32 s11, s63, 4718592
  buffer_load_dwordx4 v10, s[32:35], s11 offen  lds
  v_mfma_f32_32x32x16_bf16 v[64:79], v[132:135], v[148:151], v[64:79]
  buffer_load_dwordx4 v11, s[32:35], s11 offen offset:1024  lds
  v_mfma_f32_32x32x16_bf16 v[64:79], v[136:139], v[152:155], v[64:79]
  s_add_u32 m0, s17, 0
  s_xor_b32 s11, s62, 1152
  buffer_load_dwordx4 v8, s[20:23], s11 offen  lds
  s_waitcnt lgkmcnt(12)
  v_mfma_f32_32x32x16_bf16 v[64:79], v[140:143], v[156:159], v[64:79]
  buffer_load_dwordx4 v9, s[20:23], s11 offen offset:1024  lds
  s_waitcnt vmcnt(12)
  s_barrier
  ds_read_b128 v[144:147], v29 offset:32768
  ds_read_b64_tr_b16 v[128:129], v7 offset:32768
  ds_read_b64_tr_b16 v[130:131], v7 offset:33280
  ds_read_b128 v[148:151], v30 offset:32768
  ds_read_b64_tr_b16 v[132:133], v7 offset:34816
  ds_read_b64_tr_b16 v[134:135], v7 offset:35328
  ds_read_b128 v[152:155], v31 offset:32768
  ds_read_b64_tr_b16 v[136:137], v7 offset:36864
  ds_read_b64_tr_b16 v[138:139], v7 offset:37376
  ds_read_b128 v[156:159], v32 offset:32768
  ds_read_b64_tr_b16 v[140:141], v7 offset:38912
  ds_read_b64_tr_b16 v[142:143], v7 offset:39424
  s_waitcnt lgkmcnt(15)
  v_mfma_f32_32x32x16_bf16 v[64:79], v[160:163], v[176:179], v[64:79]
  s_add_u32 m0, s17, 24576
  s_xor_b32 s11, s63, 5242880
  buffer_load_dwordx4 v10, s[32:35], s11 offen  lds
  v_mfma_f32_32x32x16_bf16 v[64:79], v[164:167], v[180:183], v[64:79]
  buffer_load_dwordx4 v11, s[32:35], s11 offen offset:1024  lds
  v_mfma_f32_32x32x16_bf16 v[64:79], v[168:171], v[184:187], v[64:79]
  s_add_u32 m0, s17, 16384
  s_xor_b32 s11, s62, 1280
  buffer_load_dwordx4 v8, s[20:23], s11 offen  lds
  s_waitcnt lgkmcnt(12)
  v_mfma_f32_32x32x16_bf16 v[64:79], v[172:175], v[188:191], v[64:79]
  buffer_load_dwordx4 v9, s[20:23], s11 offen offset:1024  lds
  s_waitcnt vmcnt(12)
  s_barrier
  ds_read_b128 v[176:179], v29 offset:49152
  ds_read_b64_tr_b16 v[160:161], v7 offset:49152
  ds_read_b64_tr_b16 v[162:163], v7 offset:49664
  ds_read_b128 v[180:183], v30 offset:49152
  ds_read_b64_tr_b16 v[164:165], v7 offset:51200
  ds_read_b64_tr_b16 v[166:167], v7 offset:51712
  ds_read_b128 v[184:187], v31 offset:49152
  ds_read_b64_tr_b16 v[168:169], v7 offset:53248
  ds_read_b64_tr_b16 v[170:171], v7 offset:53760
  ds_read_b128 v[188:191], v32 offset:49152
  ds_read_b64_tr_b16 v[172:173], v7 offset:55296
  ds_read_b64_tr_b16 v[174:175], v7 offset:55808
  s_waitcnt lgkmcnt(15)
  v_mfma_f32_32x32x16_bf16 v[64:79], v[128:131], v[144:147], v[64:79]
  s_add_u32 m0, s17, 40960
  s_xor_b32 s11, s63, 5767168
  buffer_load_dwordx4 v10, s[32:35], s11 offen  lds
  v_mfma_f32_32x32x16_bf16 v[64:79], v[132:135], v[148:151], v[64:79]
  buffer_load_dwordx4 v11, s[32:35], s11 offen offset:1024  lds
  v_mfma_f32_32x32x16_bf16 v[64:79], v[136:139], v[152:155], v[64:79]
  s_add_u32 m0, s17, 32768
  s_xor_b32 s11, s62, 1408
  buffer_load_dwordx4 v8, s[20:23], s11 offen  lds
  s_waitcnt lgkmcnt(12)
  v_mfma_f32_32x32x16_bf16 v[64:79], v[140:143], v[156:159], v[64:79]
  buffer_load_dwordx4 v9, s[20:23], s11 offen offset:1024  lds
  s_waitcnt vmcnt(12)
  s_barrier
  v_add_u32 v29, 0x10000, v29
  v_add_u32 v30, 0x10000, v30
  v_add_u32 v31, 0x10000, v31
  v_add_u32 v32, 0x10000, v32
  v_add_u32 v7, 0x10000, v7
  ds_read_b128 v[144:147], v29 offset:0
  ds_read_b64_tr_b16 v[128:129], v7 offset:0
  ds_read_b64_tr_b16 v[130:131], v7 offset:512
  ds_read_b128 v[148:151], v30 offset:0
  ds_read_b64_tr_b16 v[132:133], v7 offset:2048
  ds_read_b64_tr_b16 v[134:135], v7 offset:2560
  ds_read_b128 v[152:155], v31 offset:0
  ds_read_b64_tr_b16 v[136:137], v7 offset:4096
  ds_read_b64_tr_b16 v[138:139], v7 offset:4608
  ds_read_b128 v[156:159], v32 offset:0
  ds_read_b64_tr_b16 v[140:141], v7 offset:6144
  ds_read_b64_tr_b16 v[142:143], v7 offset:6656
  s_waitcnt lgkmcnt(15)
  v_mfma_f32_32x32x16_bf16 v[64:79], v[160:163], v[176:179], v[64:79]
  s_add_u32 m0, s17, 57344
  s_xor_b32 s11, s63, 6291456
  buffer_load_dwordx4 v10, s[32:35], s11 offen  lds
  v_mfma_f32_32x32x16_bf16 v[64:79], v[164:167], v[180:183], v[64:79]
  buffer_load_dwordx4 v11, s[32:35], s11 offen offset:1024  lds
  v_mfma_f32_32x32x16_bf16 v[64:79], v[168:171], v[184:187], v[64:79]
  s_add_u32 m0, s17, 49152
  s_xor_b32 s11, s62, 1536
  buffer_load_dwordx4 v8, s[20:23], s11 offen  lds
  s_waitcnt lgkmcnt(12)
  v_mfma_f32_32x32x16_bf16 v[64:79], v[172:175], v[188:191], v[64:79]
  buffer_load_dwordx4 v9, s[20:23], s11 offen offset:1024  lds
  s_waitcnt vmcnt(12)
  s_barrier
  v_add_u32 v29, 0xfffe0000, v29
  v_add_u32 v30, 0xfffe0000, v30
  v_add_u32 v31, 0xfffe0000, v31
  v_add_u32 v32, 0xfffe0000, v32
  v_add_u32 v7, 0xfffe0000, v7
  ds_read_b128 v[176:179], v29 offset:0
  ds_read_b64_tr_b16 v[160:161], v7 offset:0
  ds_read_b64_tr_b16 v[162:163], v7 offset:512
  ds_read_b128 v[180:183], v30 offset:0
  ds_read_b64_tr_b16 v[164:165], v7 offset:2048
  ds_read_b64_tr_b16 v[166:167], v7 offset:2560
  ds_read_b128 v[184:187], v31 offset:0
  ds_read_b64_tr_b16 v[168:169], v7 offset:4096
  ds_read_b64_tr_b16 v[170:171], v7 offset:4608
  ds_read_b128 v[188:191], v32 offset:0
  ds_read_b64_tr_b16 v[172:173], v7 offset:6144
  ds_read_b64_tr_b16 v[174:175], v7 offset:6656
  s_waitcnt lgkmcnt(15)
  v_mfma_f32_32x32x16_bf16 v[64:79], v[128:131], v[144:147], v[64:79]
  s_add_u32 m0, s17, 73728
  s_xor_b32 s11, s63, 6815744
  buffer_load_dwordx4 v10, s[32:35], s11 offen  lds
  v_mfma_f32_32x32x16_bf16 v[64:79], v[132:135], v[148:151], v[64:79]
  buffer_load_dwordx4 v11, s[32:35], s11 offen offset:1024  lds
  v_mfma_f32_32x32x16_bf16 v[64:79], v[136:139], v[152:155], v[64:79]
  s_add_u32 m0, s17, 65536
  s_xor_b32 s11, s62, 1664
  buffer_load_dwordx4 v8, s[20:23], s11 offen  lds
  s_waitcnt lgkmcnt(12)
  v_mfma_f32_32x32x16_bf16 v[64:79], v[140:143], v[156:159], v[64:79]
  buffer_load_dwordx4 v9, s[20:23], s11 offen offset:1024  lds
  s_waitcnt vmcnt(12)
  s_barrier
  ds_read_b128 v[144:147], v29 offset:16384
  ds_read_b64_tr_b16 v[128:129], v7 offset:16384
  ds_read_b64_tr_b16 v[130:131], v7 offset:16896
  ds_read_b128 v[148:151], v30 offset:16384
  ds_read_b64_tr_b16 v[132:133], v7 offset:18432
  ds_read_b64_tr_b16 v[134:135], v7 offset:18944
  ds_read_b128 v[152:155], v31 offset:16384
  ds_read_b64_tr_b16 v[136:137], v7 offset:20480
  ds_read_b64_tr_b16 v[138:139], v7 offset:20992
  ds_read_b128 v[156:159], v32 offset:16384
  ds_read_b64_tr_b16 v[140:141], v7 offset:22528
  ds_read_b64_tr_b16 v[142:143], v7 offset:23040
  s_waitcnt lgkmcnt(15)
  v_mfma_f32_32x32x16_bf16 v[64:79], v[160:163], v[176:179], v[64:79]
  s_add_u32 m0, s17, 90112
  s_xor_b32 s11, s63, 7340032
  buffer_load_dwordx4 v10, s[32:35], s11 offen  lds
  v_mfma_f32_32x32x16_bf16 v[64:79], v[164:167], v[180:183], v[64:79]
  buffer_load_dwordx4 v11, s[32:35], s11 offen offset:1024  lds
  v_mfma_f32_32x32x16_bf16 v[64:79], v[168:171], v[184:187], v[64:79]
  s_add_u32 m0, s17, 81920
  s_xor_b32 s11, s62, 1792
  buffer_load_dwordx4 v8, s[20:23], s11 offen  lds
  s_waitcnt lgkmcnt(12)
  v_mfma_f32_32x32x16_bf16 v[64:79], v[172:175], v[188:191], v[64:79]
  buffer_load_dwordx4 v9, s[20:23], s11 offen offset:1024  lds
  s_waitcnt vmcnt(12)
  s_barrier
  ds_read_b128 v[176:179], v29 offset:32768
  ds_read_b64_tr_b16 v[160:161], v7 offset:32768
  ds_read_b64_tr_b16 v[162:163], v7 offset:33280
  ds_read_b128 v[180:183], v30 offset:32768
  ds_read_b64_tr_b16 v[164:165], v7 offset:34816
  ds_read_b64_tr_b16 v[166:167], v7 offset:35328
  ds_read_b128 v[184:187], v31 offset:32768
  ds_read_b64_tr_b16 v[168:169], v7 offset:36864
  ds_read_b64_tr_b16 v[170:171], v7 offset:37376
  ds_read_b128 v[188:191], v32 offset:32768
  ds_read_b64_tr_b16 v[172:173], v7 offset:38912
  ds_read_b64_tr_b16 v[174:175], v7 offset:39424
  s_waitcnt lgkmcnt(15)
  v_mfma_f32_32x32x16_bf16 v[64:79], v[128:131], v[144:147], v[64:79]
  s_add_u32 m0, s17, 106496
  s_xor_b32 s11, s63, 7864320
  buffer_load_dwordx4 v10, s[32:35], s11 offen  lds
  v_mfma_f32_32x32x16_bf16 v[64:79], v[132:135], v[148:151], v[64:79]
  buffer_load_dwordx4 v11, s[32:35], s11 offen offset:1024  lds
  v_mfma_f32_32x32x16_bf16 v[64:79], v[136:139], v[152:155], v[64:79]
  s_add_u32 m0, s17, 98304
  s_xor_b32 s11, s62, 1920
  buffer_load_dwordx4 v8, s[20:23], s11 offen  lds
  s_waitcnt lgkmcnt(12)
  v_mfma_f32_32x32x16_bf16 v[64:79], v[140:143], v[156:159], v[64:79]
  buffer_load_dwordx4 v9, s[20:23], s11 offen offset:1024  lds
  s_waitcnt vmcnt(12)
  s_barrier
  ds_read_b128 v[144:147], v29 offset:49152
  ds_read_b64_tr_b16 v[128:129], v7 offset:49152
  ds_read_b64_tr_b16 v[130:131], v7 offset:49664
  ds_read_b128 v[148:151], v30 offset:49152
  ds_read_b64_tr_b16 v[132:133], v7 offset:51200
  ds_read_b64_tr_b16 v[134:135], v7 offset:51712
  ds_read_b128 v[152:155], v31 offset:49152
  ds_read_b64_tr_b16 v[136:137], v7 offset:53248
  ds_read_b64_tr_b16 v[138:139], v7 offset:53760
  ds_read_b128 v[156:159], v32 offset:49152
  ds_read_b64_tr_b16 v[140:141], v7 offset:55296
  ds_read_b64_tr_b16 v[142:143], v7 offset:55808
  s_waitcnt lgkmcnt(15)
  v_mfma_f32_32x32x16_bf16 v[64:79], v[160:163], v[176:179], v[64:79]
  s_add_u32 m0, s16, 114688
  s_xor_b32 s11, s64, 0
  buffer_load_dwordx4 v12, s[24:27], s11 offen  lds
  v_mfma_f32_32x32x16_bf16 v[64:79], v[164:167], v[180:183], v[64:79]
  buffer_load_dwordx4 v13, s[24:27], s11 offen offset:1024  lds
  v_mfma_f32_32x32x16_bf16 v[64:79], v[168:171], v[184:187], v[64:79]
  buffer_load_dwordx4 v14, s[24:27], s11 offen offset:2048  lds
  s_waitcnt lgkmcnt(12)
  v_mfma_f32_32x32x16_bf16 v[64:79], v[172:175], v[188:191], v[64:79]
  buffer_load_dwordx4 v15, s[24:27], s11 offen offset:3072  lds
  s_waitcnt vmcnt(12)
  s_barrier
  v_add_u32 v29, 0x10000, v29
  v_add_u32 v30, 0x10000, v30
  v_add_u32 v31, 0x10000, v31
  v_add_u32 v32, 0x10000, v32
  v_add_u32 v7, 0x10000, v7
  ds_read_b128 v[176:179], v29 offset:0
  ds_read_b64_tr_b16 v[160:161], v7 offset:0
  ds_read_b64_tr_b16 v[162:163], v7 offset:512
  ds_read_b128 v[180:183], v30 offset:0
  ds_read_b64_tr_b16 v[164:165], v7 offset:2048
  ds_read_b64_tr_b16 v[166:167], v7 offset:2560
  ds_read_b128 v[184:187], v31 offset:0
  ds_read_b64_tr_b16 v[168:169], v7 offset:4096
  ds_read_b64_tr_b16 v[170:171], v7 offset:4608
  ds_read_b128 v[188:191], v32 offset:0
  ds_read_b64_tr_b16 v[172:173], v7 offset:6144
  ds_read_b64_tr_b16 v[174:175], v7 offset:6656
  s_waitcnt lgkmcnt(15)
  v_mfma_f32_32x32x16_bf16 v[64:79], v[128:131], v[144:147], v[64:79]
  v_mfma_f32_32x32x16_bf16 v[64:79], v[132:135], v[148:151], v[64:79]
  v_mfma_f32_32x32x16_bf16 v[64:79], v[136:139], v[152:155], v[64:79]
  s_waitcnt lgkmcnt(12)
  v_mfma_f32_32x32x16_bf16 v[64:79], v[140:143], v[156:159], v[64:79]
  s_waitcnt vmcnt(8)
  s_barrier
  ds_read_b128 v[144:147], v29 offset:16384
  ds_read_b64_tr_b16 v[128:129], v7 offset:16384
  ds_read_b64_tr_b16 v[130:131], v7 offset:16896
  ds_read_b128 v[148:151], v30 offset:16384
  ds_read_b64_tr_b16 v[132:133], v7 offset:18432
  ds_read_b64_tr_b16 v[134:135], v7 offset:18944
  ds_read_b128 v[152:155], v31 offset:16384
  ds_read_b64_tr_b16 v[136:137], v7 offset:20480
  ds_read_b64_tr_b16 v[138:139], v7 offset:20992
  ds_read_b128 v[156:159], v32 offset:16384
  ds_read_b64_tr_b16 v[140:141], v7 offset:22528
  ds_read_b64_tr_b16 v[142:143], v7 offset:23040
  s_waitcnt lgkmcnt(15)
  v_mfma_f32_32x32x16_bf16 v[64:79], v[160:163], v[176:179], v[64:79]
  v_mfma_f32_32x32x16_bf16 v[64:79], v[164:167], v[180:183], v[64:79]
  v_mfma_f32_32x32x16_bf16 v[64:79], v[168:171], v[184:187], v[64:79]
  s_waitcnt lgkmcnt(12)
  v_mfma_f32_32x32x16_bf16 v[64:79], v[172:175], v[188:191], v[64:79]
  s_waitcnt vmcnt(4)
  s_barrier
  ds_read_b128 v[176:179], v29 offset:32768
  ds_read_b64_tr_b16 v[160:161], v7 offset:32768
  ds_read_b64_tr_b16 v[162:163], v7 offset:33280
  ds_read_b128 v[180:183], v30 offset:32768
  ds_read_b64_tr_b16 v[164:165], v7 offset:34816
  ds_read_b64_tr_b16 v[166:167], v7 offset:35328
  ds_read_b128 v[184:187], v31 offset:32768
  ds_read_b64_tr_b16 v[168:169], v7 offset:36864
  ds_read_b64_tr_b16 v[170:171], v7 offset:37376
  ds_read_b128 v[188:191], v32 offset:32768
  ds_read_b64_tr_b16 v[172:173], v7 offset:38912
  ds_read_b64_tr_b16 v[174:175], v7 offset:39424
  s_waitcnt lgkmcnt(15)
  v_mfma_f32_32x32x16_bf16 v[64:79], v[128:131], v[144:147], v[64:79]
  v_mfma_f32_32x32x16_bf16 v[64:79], v[132:135], v[148:151], v[64:79]
  v_mfma_f32_32x32x16_bf16 v[64:79], v[136:139], v[152:155], v[64:79]
  s_waitcnt lgkmcnt(12)
  v_mfma_f32_32x32x16_bf16 v[64:79], v[140:143], v[156:159], v[64:79]
  s_waitcnt lgkmcnt(9)
  v_mfma_f32_32x32x16_bf16 v[64:79], v[160:163], v[176:179], v[64:79]
  s_waitcnt lgkmcnt(6)
  v_mfma_f32_32x32x16_bf16 v[64:79], v[164:167], v[180:183], v[64:79]
  s_waitcnt lgkmcnt(3)
  v_mfma_f32_32x32x16_bf16 v[64:79], v[168:171], v[184:187], v[64:79]
  s_waitcnt lgkmcnt(0)
  v_mfma_f32_32x32x16_bf16 v[64:79], v[172:175], v[188:191], v[64:79]
  s_lshl_b32 s67, s52, 1
  s_add_u32 s67, s67, s57
  s_lshl_b32 s67, s67, 7
  s_lshl_b32 s8, s53, 1
  s_add_u32 s67, s67, s8
  s_add_u32 s67, s67, s58
  s_lshl_b32 s8, s67, 11
  v_mov_b32 v4, s10
  s_nop 3
  v_pk_mul_f32 v[64:65], v[64:65], v[4:5] op_sel_hi:[1,0]
  v_pk_mul_f32 v[66:67], v[66:67], v[4:5] op_sel_hi:[1,0]
  v_pk_mul_f32 v[68:69], v[68:69], v[4:5] op_sel_hi:[1,0]
  v_pk_mul_f32 v[70:71], v[70:71], v[4:5] op_sel_hi:[1,0]
  v_pk_mul_f32 v[72:73], v[72:73], v[4:5] op_sel_hi:[1,0]
  v_pk_mul_f32 v[74:75], v[74:75], v[4:5] op_sel_hi:[1,0]
  v_pk_mul_f32 v[76:77], v[76:77], v[4:5] op_sel_hi:[1,0]
  v_pk_mul_f32 v[78:79], v[78:79], v[4:5] op_sel_hi:[1,0]
  v_cvt_pk_bf16_f32 v40, v64, v65
  v_cvt_pk_bf16_f32 v41, v66, v67
  v_cvt_pk_bf16_f32 v42, v68, v69
  v_cvt_pk_bf16_f32 v43, v70, v71
  v_cvt_pk_bf16_f32 v44, v72, v73
  v_cvt_pk_bf16_f32 v45, v74, v75
  v_cvt_pk_bf16_f32 v46, v76, v77
  v_cvt_pk_bf16_f32 v47, v78, v79
  buffer_store_dwordx4 v[40:43], v1, s[44:47], s8 offen offset:0 sc1
  buffer_store_dwordx4 v[44:47], v1, s[44:47], s8 offen offset:1024 sc1
  s_lshr_b32 s8, s67, 2
  s_lshl_b32 s8, s8, 7
  s_and_b32 s4, s67, 3
  s_lshl_b32 s4, s4, 2
  s_add_u32 s9, s4, s8
  s_add_u32 s9, s9, 10616832
  s_lshr_b32 s9, s67, 1
  s_lshl_b32 s9, s9, 7
  s_add_u32 s9, s9, 23068672
  s_add_u32 m0, s16, 131072
  s_xor_b32 s11, s64, 8192
  buffer_load_dwordx4 v12, s[24:27], s11 offen  lds
  buffer_load_dwordx4 v13, s[24:27], s11 offen offset:1024  lds
  buffer_load_dwordx4 v14, s[24:27], s11 offen offset:2048  lds
  buffer_load_dwordx4 v15, s[24:27], s11 offen offset:3072  lds
  s_lshl_b32 s67, s61, 3
  s_lshl_b32 s8, s55, 1
  s_add_u32 s67, s67, s8
  s_add_u32 s67, s67, s58
  s_lshl_b32 s6, s67, 13
  s_lshl_b32 s7, s67, 8
  s_add_u32 s7, s7, 23068672
  v_and_b32 v2, 3, v0
  v_lshlrev_b32 v2, 2, v2
  s_waitcnt vmcnt(4)
  s_barrier
  s_cmp_lg_u32 s58, 0
  s_cbranch_scc1 L_noqf
  v_mov_b32 v4, s13
  v_and_b32 v5, 31, v0
  v_lshlrev_b32 v5, 2, v5
  buffer_store_dword v4, v5, s[44:47], s9 offen sc1
L_noqf:
  s_add_u32 m0, s16, 0
  s_xor_b32 s11, s64, 16384
  buffer_load_dwordx4 v12, s[24:27], s11 offen  lds
  buffer_load_dwordx4 v13, s[24:27], s11 offen offset:1024  lds
  buffer_load_dwordx4 v14, s[24:27], s11 offen offset:2048  lds
  buffer_load_dwordx4 v15, s[24:27], s11 offen offset:3072  lds
  s_add_u32 m0, s16, 16384
  s_xor_b32 s11, s64, 24576
  buffer_load_dwordx4 v12, s[24:27], s11 offen  lds
  buffer_load_dwordx4 v13, s[24:27], s11 offen offset:1024  lds
  buffer_load_dwordx4 v14, s[24:27], s11 offen offset:2048  lds
  buffer_load_dwordx4 v15, s[24:27], s11 offen offset:3072  lds
  s_add_u32 m0, s16, 32768
  s_xor_b32 s11, s64, 32768
  buffer_load_dwordx4 v12, s[24:27], s11 offen  lds
  buffer_load_dwordx4 v13, s[24:27], s11 offen offset:1024  lds
  buffer_load_dwordx4 v14, s[24:27], s11 offen offset:2048  lds
  buffer_load_dwordx4 v15, s[24:27], s11 offen offset:3072  lds
  s_add_u32 m0, s16, 49152
  s_xor_b32 s11, s64, 40960
  buffer_load_dwordx4 v12, s[24:27], s11 offen  lds
  buffer_load_dwordx4 v13, s[24:27], s11 offen offset:1024  lds
  buffer_load_dwordx4 v14, s[24:27], s11 offen offset:2048  lds
  buffer_load_dwordx4 v15, s[24:27], s11 offen offset:3072  lds
  s_add_u32 s0, s44, s7
  s_addc_u32 s1, s45, 0
  s_load_dword s20, s[0:1], 0 glc
  s_load_dword s21, s[0:1], 128 glc
  s_add_u32 m0, s16, 65536
  s_xor_b32 s11, s64, 49152
  buffer_load_dwordx4 v12, s[24:27], s11 offen  lds
  buffer_load_dwordx4 v13, s[24:27], s11 offen offset:1024  lds
  buffer_load_dwordx4 v14, s[24:27], s11 offen offset:2048  lds
  buffer_load_dwordx4 v15, s[24:27], s11 offen offset:3072  lds
  s_add_u32 m0, s16, 81920
  s_xor_b32 s11, s64, 57344
  buffer_load_dwordx4 v12, s[24:27], s11 offen  lds
  buffer_load_dwordx4 v13, s[24:27], s11 offen offset:1024  lds
  buffer_load_dwordx4 v14, s[24:27], s11 offen offset:2048  lds
  buffer_load_dwordx4 v15, s[24:27], s11 offen offset:3072  lds
  s_mov_b32 s12, 0x200000
  s_branch L_pq_chk
L_pq:
  s_add_u32 s0, s44, s7
  s_addc_u32 s1, s45, 0
  s_waitcnt lgkmcnt(0)
  s_load_dword s20, s[0:1], 0 glc
  s_load_dword s21, s[0:1], 128 glc
L_pq_chk:
  s_waitcnt lgkmcnt(0)
  s_xor_b32 s20, s20, s14
  s_xor_b32 s21, s21, s14
  s_or_b32 s20, s20, s21
  s_cbranch_scc0 L_pq_ok
  s_sub_u32 s12, s12, 1
  s_cmp_lg_u32 s12, 0
  s_cbranch_scc1 L_pq
L_pq_ok:
  buffer_load_dwordx4 v[80:83], v1, s[44:47], s6 offen offset:0 sc1
  buffer_load_dwordx4 v[84:87], v1, s[44:47], s6 offen offset:1024 sc1
  buffer_load_dwordx4 v[88:91], v1, s[44:47], s6 offen offset:2048 sc1
  buffer_load_dwordx4 v[92:95], v1, s[44:47], s6 offen offset:3072 sc1
  s_add_u32 s6, s6, 4096
  buffer_load_dwordx4 v[96:99], v1, s[44:47], s6 offen offset:0 sc1
  buffer_load_dwordx4 v[100:103], v1, s[44:47], s6 offen offset:1024 sc1
  buffer_load_dwordx4 v[104:107], v1, s[44:47], s6 offen offset:2048 sc1
  buffer_load_dwordx4 v[108:111], v1, s[44:47], s6 offen offset:3072 sc1
  s_waitcnt vmcnt(24)
  s_barrier
  s_add_u32 m0, s16, 98304
  s_xor_b32 s11, s64, 0
  buffer_load_dwordx4 v16, s[28:31], s11 offen  lds
  buffer_load_dwordx4 v16, s[28:31], s11 offen offset:1024  lds
  buffer_load_dwordx4 v16, s[28:31], s11 offen offset:2048  lds
  buffer_load_dwordx4 v16, s[28:31], s11 offen offset:3072  lds
  v_add_u32 v21, 0x10000, v21
  v_add_u32 v22, 0x10000, v22
  v_add_u32 v23, 0x10000, v23
  v_add_u32 v24, 0x10000, v24
  v_add_u32 v25, 0x10000, v25
  v_add_u32 v26, 0x10000, v26
  v_add_u32 v27, 0x10000, v27
  v_add_u32 v28, 0x10000, v28
  ds_read_b128 a[0:3], v21 offset:49152
  ds_read_b128 a[4:7], v22 offset:49152
  ds_read_b128 a[8:11], v23 offset:49152
  ds_read_b128 a[12:15], v24 offset:49152
  ds_read_b128 a[16:19], v25 offset:49152
  ds_read_b128 a[20:23], v26 offset:49152
  ds_read_b128 a[24:27], v27 offset:49152
  ds_read_b128 a[28:31], v28 offset:49152
  v_add_u32 v21, 0x10000, v21
  v_add_u32 v22, 0x10000, v22
  v_add_u32 v23, 0x10000, v23
  v_add_u32 v24, 0x10000, v24
  v_add_u32 v25, 0x10000, v25
  v_add_u32 v26, 0x10000, v26
  v_add_u32 v27, 0x10000, v27
  v_add_u32 v28, 0x10000, v28
  ds_read_b128 a[32:35], v21 offset:0
  ds_read_b128 a[36:39], v22 offset:0
  ds_read_b128 a[40:43], v23 offset:0
  ds_read_b128 a[44:47], v24 offset:0
  ds_read_b128 a[48:51], v25 offset:0
  ds_read_b128 a[52:55], v26 offset:0
  ds_read_b128 a[56:59], v27 offset:0
  ds_read_b128 a[60:63], v28 offset:0
  v_add_u32 v21, 0xfffe0000, v21
  v_add_u32 v22, 0xfffe0000, v22
  v_add_u32 v23, 0xfffe0000, v23
  v_add_u32 v24, 0xfffe0000, v24
  v_add_u32 v25, 0xfffe0000, v25
  v_add_u32 v26, 0xfffe0000, v26
  v_add_u32 v27, 0xfffe0000, v27
  v_add_u32 v28, 0xfffe0000, v28
  ds_read_b128 a[64:67], v21 offset:0
  ds_read_b128 a[68:71], v22 offset:0
  ds_read_b128 a[72:75], v23 offset:0
  ds_read_b128 a[76:79], v24 offset:0
  ds_read_b128 a[80:83], v25 offset:0
  ds_read_b128 a[84:87], v26 offset:0
  ds_read_b128 a[88:91], v27 offset:0
  ds_read_b128 a[92:95], v28 offset:0
  ds_read_b128 a[96:99], v21 offset:16384
  ds_read_b128 a[100:103], v22 offset:16384
  ds_read_b128 a[104:107], v23 offset:16384
  ds_read_b128 a[108:111], v24 offset:16384
  ds_read_b128 a[112:115], v25 offset:16384
  ds_read_b128 a[116:119], v26 offset:16384
  ds_read_b128 a[120:123], v27 offset:16384
  ds_read_b128 a[124:127], v28 offset:16384
  s_waitcnt vmcnt(12)
  s_waitcnt lgkmcnt(15)
  s_waitcnt lgkmcnt(8)
  s_waitcnt lgkmcnt(0)
  s_barrier
  s_add_u32 m0, s16, 114688
  s_xor_b32 s11, s64, 8192
  buffer_load_dwordx4 v16, s[28:31], s11 offen  lds
  buffer_load_dwordx4 v16, s[28:31], s11 offen offset:1024  lds
  buffer_load_dwordx4 v16, s[28:31], s11 offen offset:2048  lds
  buffer_load_dwordx4 v16, s[28:31], s11 offen offset:3072  lds
  s_waitcnt vmcnt(15)
  v_mfma_f32_32x32x16_bf16 v[128:143], a[0:3], v[80:83], 0
  s_waitcnt vmcnt(14)
  v_mfma_f32_32x32x16_bf16 v[128:143], a[4:7], v[84:87], v[128:143]
  s_waitcnt vmcnt(13)
  v_mfma_f32_32x32x16_bf16 v[128:143], a[8:11], v[88:91], v[128:143]
  ds_read_b128 a[128:131], v21 offset:32768
  ds_read_b128 a[132:135], v22 offset:32768
  s_waitcnt vmcnt(12)
  v_mfma_f32_32x32x16_bf16 v[128:143], a[12:15], v[92:95], v[128:143]
  ds_read_b128 a[136:139], v23 offset:32768
  s_waitcnt vmcnt(11)
  v_mfma_f32_32x32x16_bf16 v[128:143], a[16:19], v[96:99], v[128:143]
  ds_read_b128 a[140:143], v24 offset:32768
  ds_read_b128 a[144:147], v25 offset:32768
  s_waitcnt vmcnt(10)
  v_mfma_f32_32x32x16_bf16 v[128:143], a[20:23], v[100:103], v[128:143]
  ds_read_b128 a[148:151], v26 offset:32768
  s_waitcnt vmcnt(9)
  v_mfma_f32_32x32x16_bf16 v[128:143], a[24:27], v[104:107], v[128:143]
  ds_read_b128 a[152:155], v27 offset:32768
  ds_read_b128 a[156:159], v28 offset:32768
  s_waitcnt vmcnt(8)
  v_mfma_f32_32x32x16_bf16 v[128:143], a[28:31], v[108:111], v[128:143]
  v_mfma_f32_32x32x16_bf16 v[144:159], a[32:35], v[80:83], 0
  v_mfma_f32_32x32x16_bf16 v[144:159], a[36:39], v[84:87], v[144:159]
  s_nop 9
  v_max3_f32 v37, v128, v129, v130
  v_max3_f32 v37, v37, v131, v132
  v_max3_f32 v37, v37, v133, v134
  v_max3_f32 v37, v37, v135, v136
  v_max3_f32 v37, v37, v137, v138
  v_max3_f32 v37, v37, v139, v140
  v_max3_f32 v37, v37, v141, v142
  v_max_f32 v37, v37, v143
  v_mov_b32 v39, v37
  s_nop 1
  v_permlane32_swap_b32 v37, v39
  v_mfma_f32_32x32x16_bf16 v[144:159], a[40:43], v[88:91], v[144:159]
  ds_read_b128 a[160:163], v21 offset:49152
  ds_read_b128 a[164:167], v22 offset:49152
  v_max_f32 v37, v37, v39
  v_sub_f32 v112, 0, v37
  v_mov_b32 v113, v112
  v_mov_b32 v114, v112
  v_mov_b32 v115, v112
  v_mov_b32 v116, v112
  v_mov_b32 v117, v112
  v_mov_b32 v118, v112
  v_mov_b32 v119, v112
  v_mov_b32 v120, v112
  v_mov_b32 v121, v112
  v_mfma_f32_32x32x16_bf16 v[144:159], a[44:47], v[92:95], v[144:159]
  ds_read_b128 a[168:171], v23 offset:49152
  v_mov_b32 v122, v112
  v_mov_b32 v123, v112
  v_mov_b32 v124, v112
  v_mov_b32 v125, v112
  v_mov_b32 v126, v112
  v_mov_b32 v127, v112
  v_sub_f32 v128, v128, v37
  v_sub_f32 v129, v129, v37
  v_sub_f32 v130, v130, v37
  v_sub_f32 v131, v131, v37
  v_sub_f32 v132, v132, v37
  v_mfma_f32_32x32x16_bf16 v[144:159], a[48:51], v[96:99], v[144:159]
  ds_read_b128 a[172:175], v24 offset:49152
  ds_read_b128 a[176:179], v25 offset:49152
  v_sub_f32 v133, v133, v37
  v_sub_f32 v134, v134, v37
  v_sub_f32 v135, v135, v37
  v_sub_f32 v136, v136, v37
  v_sub_f32 v137, v137, v37
  v_sub_f32 v138, v138, v37
  v_sub_f32 v139, v139, v37
  v_sub_f32 v140, v140, v37
  v_sub_f32 v141, v141, v37
  v_sub_f32 v142, v142, v37
  v_mfma_f32_32x32x16_bf16 v[144:159], a[52:55], v[100:103], v[144:159]
  ds_read_b128 a[180:183], v26 offset:49152
  v_sub_f32 v143, v143, v37
  v_exp_f32 v128, v128
  v_exp_f32 v129, v129
  v_exp_f32 v130, v130
  v_exp_f32 v131, v131
  v_exp_f32 v132, v132
  v_exp_f32 v133, v133
  v_exp_f32 v134, v134
  v_exp_f32 v135, v135
  v_mov_b32 v38, v128
  v_mov_b32 v56, v129
  v_mfma_f32_32x32x16_bf16 v[144:159], a[56:59], v[104:107], v[144:159]
  ds_read_b128 a[184:187], v27 offset:49152
  ds_read_b128 a[188:191], v28 offset:49152
  v_add_f32 v38, v38, v130
  v_add_f32 v56, v56, v131
  v_add_f32 v38, v38, v132
  v_add_f32 v56, v56, v133
  v_add_f32 v38, v38, v134
  v_add_f32 v56, v56, v135
  v_exp_f32 v136, v136
  v_exp_f32 v137, v137
  v_exp_f32 v138, v138
  v_exp_f32 v139, v139
  v_exp_f32 v140, v140
  v_mfma_f32_32x32x16_bf16 v[144:159], a[60:63], v[108:111], v[144:159]
  v_exp_f32 v141, v141
  v_exp_f32 v142, v142
  v_exp_f32 v143, v143
  v_add_f32 v38, v38, v136
  v_add_f32 v56, v56, v137
  v_add_f32 v38, v38, v138
  v_add_f32 v56, v56, v139
  v_add_f32 v38, v38, v140
  v_add_f32 v56, v56, v141
  v_add_f32 v38, v38, v142
  v_add_f32 v56, v56, v143
  v_mfma_f32_32x32x16_bf16 v[160:175], a[64:67], v[80:83], v[112:127]
  v_mfma_f32_32x32x16_bf16 v[160:175], a[68:71], v[84:87], v[160:175]
  v_add_u32 v21, 0x10000, v21
  v_sub_f32 v144, v144, v37
  v_sub_f32 v145, v145, v37
  v_sub_f32 v146, v146, v37
  v_sub_f32 v147, v147, v37
  v_sub_f32 v148, v148, v37
  v_sub_f32 v149, v149, v37
  v_mfma_f32_32x32x16_bf16 v[160:175], a[72:75], v[88:91], v[160:175]
  v_add_u32 v22, 0x10000, v22
  v_add_u32 v23, 0x10000, v23
  v_add_u32 v24, 0x10000, v24
  v_sub_f32 v150, v150, v37
  v_sub_f32 v151, v151, v37
  v_sub_f32 v152, v152, v37
  v_sub_f32 v153, v153, v37
  v_sub_f32 v154, v154, v37
  v_sub_f32 v155, v155, v37
  v_sub_f32 v156, v156, v37
  v_mfma_f32_32x32x16_bf16 v[160:175], a[76:79], v[92:95], v[160:175]
  v_add_u32 v25, 0x10000, v25
  v_add_u32 v26, 0x10000, v26
  v_add_u32 v27, 0x10000, v27
  v_sub_f32 v157, v157, v37
  v_sub_f32 v158, v158, v37
  v_sub_f32 v159, v159, v37
  v_exp_f32 v144, v144
  v_exp_f32 v145, v145
  v_exp_f32 v146, v146
  v_exp_f32 v147, v147
  v_mfma_f32_32x32x16_bf16 v[160:175], a[80:83], v[96:99], v[160:175]
  v_add_u32 v28, 0x10000, v28
  ds_read_b128 a[192:195], v21 offset:0
  ds_read_b128 a[196:199], v22 offset:0
  v_exp_f32 v148, v148
  v_exp_f32 v149, v149
  v_exp_f32 v150, v150
  v_exp_f32 v151, v151
  v_add_f32 v38, v38, v144
  v_add_f32 v56, v56, v145
  v_add_f32 v38, v38, v146
  v_mfma_f32_32x32x16_bf16 v[160:175], a[84:87], v[100:103], v[160:175]
  ds_read_b128 a[200:203], v23 offset:0
  ds_read_b128 a[204:207], v24 offset:0
  ds_read_b128 a[208:211], v25 offset:0
  v_add_f32 v56, v56, v147
  v_add_f32 v38, v38, v148
  v_add_f32 v56, v56, v149
  v_add_f32 v38, v38, v150
  v_add_f32 v56, v56, v151
  v_exp_f32 v152, v152
  v_exp_f32 v153, v153
  v_mfma_f32_32x32x16_bf16 v[160:175], a[88:91], v[104:107], v[160:175]
  ds_read_b128 a[212:215], v26 offset:0
  ds_read_b128 a[216:219], v27 offset:0
  ds_read_b128 a[220:223], v28 offset:0
  v_exp_f32 v154, v154
  v_exp_f32 v155, v155
  v_exp_f32 v156, v156
  v_exp_f32 v157, v157
  v_exp_f32 v158, v158
  v_exp_f32 v159, v159
  v_add_f32 v38, v38, v152
  v_mfma_f32_32x32x16_bf16 v[160:175], a[92:95], v[108:111], v[160:175]
  v_add_f32 v56, v56, v153
  v_add_f32 v38, v38, v154
  v_add_f32 v56, v56, v155
  v_add_f32 v38, v38, v156
  v_add_f32 v56, v56, v157
  v_add_f32 v38, v38, v158
  v_add_f32 v56, v56, v159
  v_mfma_f32_32x32x16_bf16 v[176:191], a[96:99], v[80:83], v[112:127]
  v_mfma_f32_32x32x16_bf16 v[176:191], a[100:103], v[84:87], v[176:191]
  s_add_u32 m0, s16, 131072
  s_xor_b32 s11, s64, 16384
  buffer_load_dwordx4 v16, s[28:31], s11 offen  lds
  v_exp_f32 v160, v160
  v_exp_f32 v161, v161
  v_exp_f32 v162, v162
  v_exp_f32 v163, v163
  v_mfma_f32_32x32x16_bf16 v[176:191], a[104:107], v[88:91], v[176:191]
  ds_read_b128 a[224:227], v21 offset:16384
  ds_read_b128 a[228:231], v22 offset:16384
  v_exp_f32 v164, v164
  v_exp_f32 v165, v165
  v_exp_f32 v166, v166
  v_exp_f32 v167, v167
  v_add_f32 v38, v38, v160
  v_mfma_f32_32x32x16_bf16 v[176:191], a[108:111], v[92:95], v[176:191]
  ds_read_b128 a[232:235], v23 offset:16384
  buffer_load_dwordx4 v16, s[28:31], s11 offen offset:1024  lds
  v_add_f32 v56, v56, v161
  v_add_f32 v38, v38, v162
  v_add_f32 v56, v56, v163
  v_add_f32 v38, v38, v164
  v_mfma_f32_32x32x16_bf16 v[176:191], a[112:115], v[96:99], v[176:191]
  ds_read_b128 a[236:239], v24 offset:16384
  ds_read_b128 a[240:243], v25 offset:16384
  v_add_f32 v56, v56, v165
  v_add_f32 v38, v38, v166
  v_add_f32 v56, v56, v167
  v_exp_f32 v168, v168
  v_exp_f32 v169, v169
  v_mfma_f32_32x32x16_bf16 v[176:191], a[116:119], v[100:103], v[176:191]
  ds_read_b128 a[244:247], v26 offset:16384
  buffer_load_dwordx4 v16, s[28:31], s11 offen offset:2048  lds
  v_exp_f32 v170, v170
  v_exp_f32 v171, v171
  v_exp_f32 v172, v172
  v_exp_f32 v173, v173
  v_mfma_f32_32x32x16_bf16 v[176:191], a[120:123], v[104:107], v[176:191]
  ds_read_b128 a[248:251], v27 offset:16384
  ds_read_b128 a[252:255], v28 offset:16384
  v_exp_f32 v174, v174
  v_exp_f32 v175, v175
  v_add_f32 v38, v38, v168
  v_add_f32 v56, v56, v169
  v_add_f32 v38, v38, v170
  v_mfma_f32_32x32x16_bf16 v[176:191], a[124:127], v[108:111], v[176:191]
  buffer_load_dwordx4 v16, s[28:31], s11 offen offset:3072  lds
  v_add_f32 v56, v56, v171
  v_add_f32 v38, v38, v172
  v_add_f32 v56, v56, v173
  v_add_f32 v38, v38, v174
  v_add_f32 v56, v56, v175
  s_waitcnt lgkmcnt(15)
  v_mfma_f32_32x32x16_bf16 v[192:207], a[128:131], v[80:83], v[112:127]
  v_mfma_f32_32x32x16_bf16 v[192:207], a[132:135], v[84:87], v[192:207]
  s_add_u32 m0, s16, 0
  s_xor_b32 s11, s64, 24576
  buffer_load_dwordx4 v16, s[28:31], s11 offen  lds
  v_exp_f32 v176, v176
  v_exp_f32 v177, v177
  v_exp_f32 v178, v178
  v_exp_f32 v179, v179
  v_mfma_f32_32x32x16_bf16 v[192:207], a[136:139], v[88:91], v[192:207]
  v_exp_f32 v180, v180
  v_exp_f32 v181, v181
  v_exp_f32 v182, v182
  v_exp_f32 v183, v183
  v_add_f32 v38, v38, v176
  v_mfma_f32_32x32x16_bf16 v[192:207], a[140:143], v[92:95], v[192:207]
  buffer_load_dwordx4 v16, s[28:31], s11 offen offset:1024  lds
  v_add_f32 v56, v56, v177
  v_add_f32 v38, v38, v178
  v_add_f32 v56, v56, v179
  v_add_f32 v38, v38, v180
  v_mfma_f32_32x32x16_bf16 v[192:207], a[144:147], v[96:99], v[192:207]
  v_add_f32 v56, v56, v181
  v_add_f32 v38, v38, v182
  v_add_f32 v56, v56, v183
  v_exp_f32 v184, v184
  v_exp_f32 v185, v185
  v_mfma_f32_32x32x16_bf16 v[192:207], a[148:151], v[100:103], v[192:207]
  buffer_load_dwordx4 v16, s[28:31], s11 offen offset:2048  lds
  v_exp_f32 v186, v186
  v_exp_f32 v187, v187
  v_exp_f32 v188, v188
  v_exp_f32 v189, v189
  v_mfma_f32_32x32x16_bf16 v[192:207], a[152:155], v[104:107], v[192:207]
  v_exp_f32 v190, v190
  v_exp_f32 v191, v191
  v_add_f32 v38, v38, v184
  v_add_f32 v56, v56, v185
  v_add_f32 v38, v38, v186
  v_mfma_f32_32x32x16_bf16 v[192:207], a[156:159], v[108:111], v[192:207]
  buffer_load_dwordx4 v16, s[28:31], s11 offen offset:3072  lds
  v_add_f32 v56, v56, v187
  v_add_f32 v38, v38, v188
  v_add_f32 v56, v56, v189
  v_add_f32 v38, v38, v190
  v_add_f32 v56, v56, v191
  s_waitcnt lgkmcnt(8)
  s_waitcnt lgkmcnt(0)
  s_barrier
  v_mfma_f32_32x32x16_bf16 v[208:223], a[160:163], v[80:83], v[112:127]
  v_mfma_f32_32x32x16_bf16 v[208:223], a[164:167], v[84:87], v[208:223]
  s_add_u32 m0, s16, 16384
  s_xor_b32 s11, s64, 32768
  buffer_load_dwordx4 v16, s[28:31], s11 offen  lds
  v_exp_f32 v192, v192
  v_exp_f32 v193, v193
  v_exp_f32 v194, v194
  v_exp_f32 v195, v195
  v_mfma_f32_32x32x16_bf16 v[208:223], a[168:171], v[88:91], v[208:223]
  v_exp_f32 v196, v196
  v_exp_f32 v197, v197
  v_exp_f32 v198, v198
  v_exp_f32 v199, v199
  v_add_f32 v38, v38, v192
  v_mfma_f32_32x32x16_bf16 v[208:223], a[172:175], v[92:95], v[208:223]
  buffer_load_dwordx4 v16, s[28:31], s11 offen offset:1024  lds
  v_add_f32 v56, v56, v193
  v_add_f32 v38, v38, v194
  v_add_f32 v56, v56, v195
  v_add_f32 v38, v38, v196
  v_mfma_f32_32x32x16_bf16 v[208:223], a[176:179], v[96:99], v[208:223]
  v_add_f32 v56, v56, v197
  v_add_f32 v38, v38, v198
  v_add_f32 v56, v56, v199
  v_exp_f32 v200, v200
  v_exp_f32 v201, v201
  v_mfma_f32_32x32x16_bf16 v[208:223], a[180:183], v[100:103], v[208:223]
  buffer_load_dwordx4 v16, s[28:31], s11 offen offset:2048  lds
  v_exp_f32 v202, v202
  v_exp_f32 v203, v203
  v_exp_f32 v204, v204
  v_exp_f32 v205, v205
  v_mfma_f32_32x32x16_bf16 v[208:223], a[184:187], v[104:107], v[208:223]
  v_exp_f32 v206, v206
  v_exp_f32 v207, v207
  v_add_f32 v38, v38, v200
  v_add_f32 v56, v56, v201
  v_add_f32 v38, v38, v202
  v_mfma_f32_32x32x16_bf16 v[208:223], a[188:191], v[108:111], v[208:223]
  buffer_load_dwordx4 v16, s[28:31], s11 offen offset:3072  lds
  v_add_f32 v56, v56, v203
  v_add_f32 v38, v38, v204
  v_add_f32 v56, v56, v205
  v_add_f32 v38, v38, v206
  v_add_f32 v56, v56, v207
  v_mfma_f32_32x32x16_bf16 v[224:239], a[192:195], v[80:83], v[112:127]
  v_mfma_f32_32x32x16_bf16 v[224:239], a[196:199], v[84:87], v[224:239]
  s_add_u32 m0, s16, 32768
  s_xor_b32 s11, s64, 40960
  buffer_load_dwordx4 v16, s[28:31], s11 offen  lds
  s_nop 0
  v_exp_f32 v208, v208
  v_exp_f32 v209, v209
  v_exp_f32 v210, v210
  v_exp_f32 v211, v211
  v_mfma_f32_32x32x16_bf16 v[224:239], a[200:203], v[88:91], v[224:239]
  v_exp_f32 v212, v212
  v_exp_f32 v213, v213
  v_exp_f32 v214, v214
  v_exp_f32 v215, v215
  v_add_f32 v38, v38, v208
  v_mfma_f32_32x32x16_bf16 v[224:239], a[204:207], v[92:95], v[224:239]
  buffer_load_dwordx4 v16, s[28:31], s11 offen offset:1024  lds
  v_add_f32 v56, v56, v209
  v_add_f32 v38, v38, v210
  v_add_f32 v56, v56, v211
  v_add_f32 v38, v38, v212
  v_mfma_f32_32x32x16_bf16 v[224:239], a[208:211], v[96:99], v[224:239]
  v_add_f32 v56, v56, v213
  v_add_f32 v38, v38, v214
  v_add_f32 v56, v56, v215
  v_exp_f32 v216, v216
  v_exp_f32 v217, v217
  v_mfma_f32_32x32x16_bf16 v[224:239], a[212:215], v[100:103], v[224:239]
  buffer_load_dwordx4 v16, s[28:31], s11 offen offset:2048  lds
  v_exp_f32 v218, v218
  v_exp_f32 v219, v219
  v_exp_f32 v220, v220
  v_exp_f32 v221, v221
  v_mfma_f32_32x32x16_bf16 v[224:239], a[216:219], v[104:107], v[224:239]
  v_exp_f32 v222, v222
  v_exp_f32 v223, v223
  v_add_f32 v38, v38, v216
  v_add_f32 v56, v56, v217
  v_add_f32 v38, v38, v218
  v_mfma_f32_32x32x16_bf16 v[224:239], a[220:223], v[108:111], v[224:239]
  buffer_load_dwordx4 v16, s[28:31], s11 offen offset:3072  lds
  v_add_f32 v56, v56, v219
  v_add_f32 v38, v38, v220
  v_add_f32 v56, v56, v221
  v_add_f32 v38, v38, v222
  v_add_f32 v56, v56, v223
  s_waitcnt vmcnt(8)
  s_barrier
  v_mfma_f32_32x32x16_bf16 v[240:255], a[224:227], v[80:83], v[112:127]
  s_add_u32 m0, s16, 49152
  s_xor_b32 s11, s64, 49152
  buffer_load_dwordx4 v16, s[28:31], s11 offen  lds
  v_mfma_f32_32x32x16_bf16 v[240:255], a[228:231], v[84:87], v[240:255]
  v_add_u32 v33, 0x10000, v33
  v_add_u32 v34, 0x10000, v34
  buffer_load_dwordx4 v16, s[28:31], s11 offen offset:1024  lds
  v_exp_f32 v224, v224
  v_exp_f32 v225, v225
  v_exp_f32 v226, v226
  v_exp_f32 v227, v227
  v_exp_f32 v228, v228
  v_mfma_f32_32x32x16_bf16 v[240:255], a[232:235], v[88:91], v[240:255]
  v_add_u32 v35, 0x10000, v35
  v_add_u32 v36, 0x10000, v36
  ds_read_b64_tr_b16 a[192:193], v33 offset:32768
  ds_read_b64_tr_b16 a[194:195], v33 offset:34816
  buffer_load_dwordx4 v16, s[28:31], s11 offen offset:2048  lds
  v_exp_f32 v229, v229
  v_exp_f32 v230, v230
  v_exp_f32 v231, v231
  v_add_f32 v38, v38, v224
  v_add_f32 v56, v56, v225
  v_mfma_f32_32x32x16_bf16 v[240:255], a[236:239], v[92:95], v[240:255]
  ds_read_b64_tr_b16 a[196:197], v35 offset:32768
  ds_read_b64_tr_b16 a[198:199], v35 offset:34816
  ds_read_b64_tr_b16 a[0:1], v34 offset:32768
  ds_read_b64_tr_b16 a[2:3], v34 offset:34816
  buffer_load_dwordx4 v16, s[28:31], s11 offen offset:3072  lds
  v_add_f32 v38, v38, v226
  v_add_f32 v56, v56, v227
  v_add_f32 v38, v38, v228
  v_add_f32 v56, v56, v229
  v_add_f32 v38, v38, v230
  v_mfma_f32_32x32x16_bf16 v[240:255], a[240:243], v[96:99], v[240:255]
  ds_read_b64_tr_b16 a[4:5], v36 offset:32768
  ds_read_b64_tr_b16 a[6:7], v36 offset:34816
  s_add_u32 m0, s16, 65536
  s_xor_b32 s11, s64, 57344
  buffer_load_dwordx4 v16, s[28:31], s11 offen  lds
  v_add_f32 v56, v56, v231
  v_exp_f32 v232, v232
  v_exp_f32 v233, v233
  v_exp_f32 v234, v234
  v_exp_f32 v235, v235
  v_mfma_f32_32x32x16_bf16 v[240:255], a[244:247], v[100:103], v[240:255]
  ds_read_b64_tr_b16 a[200:201], v33 offset:36864
  ds_read_b64_tr_b16 a[202:203], v33 offset:38912
  ds_read_b64_tr_b16 a[204:205], v35 offset:36864
  ds_read_b64_tr_b16 a[206:207], v35 offset:38912
  buffer_load_dwordx4 v16, s[28:31], s11 offen offset:1024  lds
  v_exp_f32 v236, v236
  v_exp_f32 v237, v237
  v_exp_f32 v238, v238
  v_exp_f32 v239, v239
  v_add_f32 v38, v38, v232
  v_mfma_f32_32x32x16_bf16 v[240:255], a[248:251], v[104:107], v[240:255]
  ds_read_b64_tr_b16 a[8:9], v34 offset:36864
  ds_read_b64_tr_b16 a[10:11], v34 offset:38912
  ds_read_b64_tr_b16 a[12:13], v36 offset:36864
  ds_read_b64_tr_b16 a[14:15], v36 offset:38912
  buffer_load_dwordx4 v16, s[28:31], s11 offen offset:2048  lds
  v_add_f32 v56, v56, v233
  v_add_f32 v38, v38, v234
  v_add_f32 v56, v56, v235
  v_add_f32 v38, v38, v236
  v_add_f32 v56, v56, v237
  v_mfma_f32_32x32x16_bf16 v[240:255], a[252:255], v[108:111], v[240:255]
  buffer_load_dwordx4 v16, s[28:31], s11 offen offset:3072  lds
  v_add_f32 v38, v38, v238
  v_add_f32 v56, v56, v239
  v_cvt_pk_bf16_f32 v128, v128, v129
  v_cvt_pk_bf16_f32 v129, v130, v131
  v_cvt_pk_bf16_f32 v130, v132, v133
  v_cvt_pk_bf16_f32 v131, v134, v135
  v_add_f32 v48, v38, v56
  v_mov_b32 v49, 0x49800000
  v_mov_b32 v50, 0x41a00000
  v_cmp_nle_f32 s[4:5], v48, v49
  s_nop 0
  v_max3_f32 v39, v240, v241, v242
  v_max3_f32 v39, v39, v243, v244
  v_max3_f32 v39, v39, v245, v246
  v_max3_f32 v39, v39, v247, v248
  v_max3_f32 v39, v39, v249, v250
  v_max3_f32 v39, v39, v251, v252
  v_max3_f32 v39, v39, v253, v254
  v_max_f32 v39, v39, v255
  v_cmp_nle_f32 vcc, v39, v50
  s_nop 0
  s_or_b64 vcc, vcc, s[4:5]
  s_cbranch_vccnz L_fb
L_fb_ret:
  s_waitcnt lgkmcnt(12)
  v_mfma_f32_32x32x16_bf16 v[96:111], a[196:199], v[128:131], 0
  ds_read_b64_tr_b16 a[208:209], v33 offset:49152
  ds_read_b64_tr_b16 a[210:211], v33 offset:51200
  ds_read_b64_tr_b16 a[212:213], v35 offset:49152
  s_add_u32 m0, s16, 81920
  s_xor_b32 s11, s65, 0
  buffer_load_dwordx4 v17, s[36:39], s11 offen  lds
  v_cvt_pk_bf16_f32 v136, v136, v137
  v_cvt_pk_bf16_f32 v137, v138, v139
  v_cvt_pk_bf16_f32 v138, v140, v141
  v_cvt_pk_bf16_f32 v139, v142, v143
  v_mfma_f32_32x32x16_bf16 v[64:79], a[192:195], v[128:131], 0
  ds_read_b64_tr_b16 a[214:215], v35 offset:51200
  ds_read_b64_tr_b16 a[16:17], v34 offset:49152
  ds_read_b64_tr_b16 a[18:19], v34 offset:51200
  ds_read_b64_tr_b16 a[20:21], v36 offset:49152
  ds_read_b64_tr_b16 a[22:23], v36 offset:51200
  buffer_load_dwordx4 v18, s[36:39], s11 offen offset:1024  lds
  v_mov_b32 v21, v3
  v_xor_b32 v22, 64, v3
  v_xor_b32 v23, 128, v3
  v_xor_b32 v24, 192, v3
  s_waitcnt lgkmcnt(12)
  v_mfma_f32_32x32x16_bf16 v[96:111], a[204:207], v[136:139], v[96:111]
  ds_read_b64_tr_b16 a[216:217], v33 offset:53248
  ds_read_b64_tr_b16 a[218:219], v33 offset:55296
  ds_read_b64_tr_b16 a[220:221], v35 offset:53248
  buffer_load_dwordx4 v19, s[36:39], s11 offen offset:2048  lds
  v_cvt_pk_bf16_f32 v144, v144, v145
  v_cvt_pk_bf16_f32 v145, v146, v147
  v_cvt_pk_bf16_f32 v146, v148, v149
  v_cvt_pk_bf16_f32 v147, v150, v151
  v_mfma_f32_32x32x16_bf16 v[64:79], a[200:203], v[136:139], v[64:79]
  ds_read_b64_tr_b16 a[222:223], v35 offset:55296
  ds_read_b64_tr_b16 a[24:25], v34 offset:53248
  ds_read_b64_tr_b16 a[26:27], v34 offset:55296
  ds_read_b64_tr_b16 a[28:29], v36 offset:53248
  ds_read_b64_tr_b16 a[30:31], v36 offset:55296
  buffer_load_dwordx4 v20, s[36:39], s11 offen offset:3072  lds
  v_exp_f32 v240, v240
  v_exp_f32 v241, v241
  v_exp_f32 v242, v242
  v_exp_f32 v243, v243
  s_waitcnt lgkmcnt(12)
  v_mfma_f32_32x32x16_bf16 v[96:111], a[212:215], v[144:147], v[96:111]
  v_add_u32 v33, 0x10000, v33
  v_add_u32 v34, 0x10000, v34
  v_add_u32 v35, 0x10000, v35
  v_add_u32 v36, 0x10000, v36
  ds_read_b64_tr_b16 a[192:193], v33 offset:0
  v_cvt_pk_bf16_f32 v152, v152, v153
  v_cvt_pk_bf16_f32 v153, v154, v155
  v_cvt_pk_bf16_f32 v154, v156, v157
  v_cvt_pk_bf16_f32 v155, v158, v159
  v_mfma_f32_32x32x16_bf16 v[64:79], a[208:211], v[144:147], v[64:79]
  ds_read_b64_tr_b16 a[194:195], v33 offset:2048
  ds_read_b64_tr_b16 a[196:197], v35 offset:0
  ds_read_b64_tr_b16 a[198:199], v35 offset:2048
  ds_read_b64_tr_b16 a[32:33], v34 offset:0
  ds_read_b64_tr_b16 a[34:35], v34 offset:2048
  ds_read_b64_tr_b16 a[36:37], v36 offset:0
  ds_read_b64_tr_b16 a[38:39], v36 offset:2048
  v_exp_f32 v244, v244
  v_exp_f32 v245, v245
  v_exp_f32 v246, v246
  v_exp_f32 v247, v247
  s_waitcnt lgkmcnt(12)
  v_mfma_f32_32x32x16_bf16 v[96:111], a[220:223], v[152:155], v[96:111]
  ds_read_b64_tr_b16 a[200:201], v33 offset:4096
  ds_read_b64_tr_b16 a[202:203], v33 offset:6144
  ds_read_b64_tr_b16 a[204:205], v35 offset:4096
  v_cvt_pk_bf16_f32 v160, v160, v161
  v_cvt_pk_bf16_f32 v161, v162, v163
  v_cvt_pk_bf16_f32 v162, v164, v165
  v_cvt_pk_bf16_f32 v163, v166, v167
  v_mfma_f32_32x32x16_bf16 v[64:79], a[216:219], v[152:155], v[64:79]
  ds_read_b64_tr_b16 a[206:207], v35 offset:6144
  ds_read_b64_tr_b16 a[40:41], v34 offset:4096
  ds_read_b64_tr_b16 a[42:43], v34 offset:6144
  ds_read_b64_tr_b16 a[44:45], v36 offset:4096
  ds_read_b64_tr_b16 a[46:47], v36 offset:6144
  v_add_f32 v38, v38, v240
  v_add_f32 v56, v56, v241
  v_add_f32 v38, v38, v242
  v_add_f32 v56, v56, v243
  s_waitcnt lgkmcnt(12)
  v_mfma_f32_32x32x16_bf16 v[96:111], a[196:199], v[160:163], v[96:111]
  v_add_u32 v33, 0xfffe0000, v33
  v_add_u32 v34, 0xfffe0000, v34
  v_add_u32 v35, 0xfffe0000, v35
  v_add_u32 v36, 0xfffe0000, v36
  ds_read_b64_tr_b16 a[208:209], v33 offset:0
  v_cvt_pk_bf16_f32 v168, v168, v169
  v_cvt_pk_bf16_f32 v169, v170, v171
  v_cvt_pk_bf16_f32 v170, v172, v173
  v_cvt_pk_bf16_f32 v171, v174, v175
  v_mfma_f32_32x32x16_bf16 v[64:79], a[192:195], v[160:163], v[64:79]
  ds_read_b64_tr_b16 a[210:211], v33 offset:2048
  ds_read_b64_tr_b16 a[212:213], v35 offset:0
  ds_read_b64_tr_b16 a[214:215], v35 offset:2048
  ds_read_b64_tr_b16 a[48:49], v34 offset:0
  ds_read_b64_tr_b16 a[50:51], v34 offset:2048
  ds_read_b64_tr_b16 a[52:53], v36 offset:0
  ds_read_b64_tr_b16 a[54:55], v36 offset:2048
  v_add_f32 v38, v38, v244
  v_add_f32 v56, v56, v245
  v_add_f32 v38, v38, v246
  v_add_f32 v56, v56, v247
  s_waitcnt lgkmcnt(12)
  v_mfma_f32_32x32x16_bf16 v[96:111], a[204:207], v[168:171], v[96:111]
  ds_read_b64_tr_b16 a[216:217], v33 offset:4096
  ds_read_b64_tr_b16 a[218:219], v33 offset:6144
  ds_read_b64_tr_b16 a[220:221], v35 offset:4096
  v_cvt_pk_bf16_f32 v176, v176, v177
  v_cvt_pk_bf16_f32 v177, v178, v179
  v_cvt_pk_bf16_f32 v178, v180, v181
  v_cvt_pk_bf16_f32 v179, v182, v183
  v_mfma_f32_32x32x16_bf16 v[64:79], a[200:203], v[168:171], v[64:79]
  ds_read_b64_tr_b16 a[222:223], v35 offset:6144
  ds_read_b64_tr_b16 a[56:57], v34 offset:4096
  ds_read_b64_tr_b16 a[58:59], v34 offset:6144
  ds_read_b64_tr_b16 a[60:61], v36 offset:4096
  ds_read_b64_tr_b16 a[62:63], v36 offset:6144
  v_exp_f32 v248, v248
  v_exp_f32 v249, v249
  v_exp_f32 v250, v250
  v_exp_f32 v251, v251
  s_waitcnt vmcnt(4)
  s_waitcnt lgkmcnt(15)
  s_waitcnt lgkmcnt(0)
  s_barrier
  v_mfma_f32_32x32x16_bf16 v[96:111], a[212:215], v[176:179], v[96:111]
  ds_read_b64_tr_b16 a[192:193], v33 offset:16384
  ds_read_b64_tr_b16 a[194:195], v33 offset:18432
  ds_read_b64_tr_b16 a[196:197], v35 offset:16384
  s_add_u32 m0, s16, 131072
  s_xor_b32 s11, s65, 65536
  buffer_load_dwordx4 v17, s[36:39], s11 offen  lds
  v_cvt_pk_bf16_f32 v184, v184, v185
  v_cvt_pk_bf16_f32 v185, v186, v187
  v_cvt_pk_bf16_f32 v186, v188, v189
  v_cvt_pk_bf16_f32 v187, v190, v191
  v_mfma_f32_32x32x16_bf16 v[64:79], a[208:211], v[176:179], v[64:79]
  ds_read_b64_tr_b16 a[198:199], v35 offset:18432
  ds_read_b64_tr_b16 a[64:65], v34 offset:16384
  ds_read_b64_tr_b16 a[66:67], v34 offset:18432
  ds_read_b64_tr_b16 a[68:69], v36 offset:16384
  ds_read_b64_tr_b16 a[70:71], v36 offset:18432
  buffer_load_dwordx4 v18, s[36:39], s11 offen offset:1024  lds
  v_exp_f32 v252, v252
  v_exp_f32 v253, v253
  v_exp_f32 v254, v254
  v_exp_f32 v255, v255
  v_mfma_f32_32x32x16_bf16 v[96:111], a[220:223], v[184:187], v[96:111]
  ds_read_b64_tr_b16 a[200:201], v33 offset:20480
  ds_read_b64_tr_b16 a[202:203], v33 offset:22528
  ds_read_b64_tr_b16 a[204:205], v35 offset:20480
  buffer_load_dwordx4 v19, s[36:39], s11 offen offset:2048  lds
  v_cvt_pk_bf16_f32 v192, v192, v193
  v_cvt_pk_bf16_f32 v193, v194, v195
  v_cvt_pk_bf16_f32 v194, v196, v197
  v_cvt_pk_bf16_f32 v195, v198, v199
  v_mfma_f32_32x32x16_bf16 v[64:79], a[216:219], v[184:187], v[64:79]
  ds_read_b64_tr_b16 a[206:207], v35 offset:22528
  ds_read_b64_tr_b16 a[72:73], v34 offset:20480
  ds_read_b64_tr_b16 a[74:75], v34 offset:22528
  ds_read_b64_tr_b16 a[76:77], v36 offset:20480
  ds_read_b64_tr_b16 a[78:79], v36 offset:22528
  buffer_load_dwordx4 v20, s[36:39], s11 offen offset:3072  lds
  v_add_f32 v38, v38, v248
  v_add_f32 v56, v56, v249
  v_add_f32 v38, v38, v250
  v_add_f32 v56, v56, v251
  s_waitcnt lgkmcnt(12)
  v_mfma_f32_32x32x16_bf16 v[96:111], a[196:199], v[192:195], v[96:111]
  ds_read_b64_tr_b16 a[208:209], v33 offset:32768
  ds_read_b64_tr_b16 a[210:211], v33 offset:34816
  ds_read_b64_tr_b16 a[212:213], v35 offset:32768
  v_cvt_pk_bf16_f32 v200, v200, v201
  v_cvt_pk_bf16_f32 v201, v202, v203
  v_cvt_pk_bf16_f32 v202, v204, v205
  v_cvt_pk_bf16_f32 v203, v206, v207
  v_mfma_f32_32x32x16_bf16 v[64:79], a[192:195], v[192:195], v[64:79]
  ds_read_b64_tr_b16 a[214:215], v35 offset:34816
  ds_read_b64_tr_b16 a[80:81], v34 offset:32768
  ds_read_b64_tr_b16 a[82:83], v34 offset:34816
  ds_read_b64_tr_b16 a[84:85], v36 offset:32768
  ds_read_b64_tr_b16 a[86:87], v36 offset:34816
  v_add_f32 v38, v38, v252
  v_add_f32 v56, v56, v253
  v_add_f32 v38, v38, v254
  v_add_f32 v56, v56, v255
  s_waitcnt lgkmcnt(12)
  v_mfma_f32_32x32x16_bf16 v[96:111], a[204:207], v[200:203], v[96:111]
  ds_read_b64_tr_b16 a[216:217], v33 offset:36864
  ds_read_b64_tr_b16 a[218:219], v33 offset:38912
  ds_read_b64_tr_b16 a[220:221], v35 offset:36864
  v_cvt_pk_bf16_f32 v208, v208, v209
  v_cvt_pk_bf16_f32 v209, v210, v211
  v_cvt_pk_bf16_f32 v210, v212, v213
  v_cvt_pk_bf16_f32 v211, v214, v215
  v_mfma_f32_32x32x16_bf16 v[64:79], a[200:203], v[200:203], v[64:79]
  ds_read_b64_tr_b16 a[222:223], v35 offset:38912
  ds_read_b64_tr_b16 a[88:89], v34 offset:36864
  ds_read_b64_tr_b16 a[90:91], v34 offset:38912
  ds_read_b64_tr_b16 a[92:93], v36 offset:36864
  ds_read_b64_tr_b16 a[94:95], v36 offset:38912
  v_add_f32 v38, v38, v56
  v_mov_b32 v6, v38
  s_nop 1
  v_permlane32_swap_b32 v38, v6
  v_add_f32 v38, v38, v6
  s_waitcnt lgkmcnt(12)
  v_mfma_f32_32x32x16_bf16 v[96:111], a[212:215], v[208:211], v[96:111]
  ds_read_b64_tr_b16 a[192:193], v33 offset:49152
  ds_read_b64_tr_b16 a[194:195], v33 offset:51200
  ds_read_b64_tr_b16 a[196:197], v35 offset:49152
  v_cvt_pk_bf16_f32 v216, v216, v217
  v_cvt_pk_bf16_f32 v217, v218, v219
  v_cvt_pk_bf16_f32 v218, v220, v221
  v_mfma_f32_32x32x16_bf16 v[64:79], a[208:211], v[208:211], v[64:79]
  ds_read_b64_tr_b16 a[198:199], v35 offset:51200
  ds_read_b64_tr_b16 a[96:97], v34 offset:49152
  ds_read_b64_tr_b16 a[98:99], v34 offset:51200
  ds_read_b64_tr_b16 a[100:101], v36 offset:49152
  ds_read_b64_tr_b16 a[102:103], v36 offset:51200
  v_cvt_pk_bf16_f32 v219, v222, v223
  v_mov_b32 v4, v37
  v_mov_b32 v5, v38
  s_lshl_b32 s67, s48, 10
  s_add_u32 s67, s67, 147456
  v_add_u32 v2, s67, v1
  ds_write_b64 v2, v[4:5]
  v_xor_b32 v2, 2048, v2
  s_waitcnt lgkmcnt(13)
  v_mfma_f32_32x32x16_bf16 v[96:111], a[220:223], v[216:219], v[96:111]
  ds_read_b64_tr_b16 a[200:201], v33 offset:53248
  ds_read_b64_tr_b16 a[202:203], v33 offset:55296
  ds_read_b64_tr_b16 a[204:205], v35 offset:53248
  v_cvt_pk_bf16_f32 v224, v224, v225
  v_cvt_pk_bf16_f32 v225, v226, v227
  v_mfma_f32_32x32x16_bf16 v[64:79], a[216:219], v[216:219], v[64:79]
  ds_read_b64_tr_b16 a[206:207], v35 offset:55296
  ds_read_b64_tr_b16 a[104:105], v34 offset:53248
  ds_read_b64_tr_b16 a[106:107], v34 offset:55296
  ds_read_b64_tr_b16 a[108:109], v36 offset:53248
  ds_read_b64_tr_b16 a[110:111], v36 offset:55296
  v_cvt_pk_bf16_f32 v226, v228, v229
  v_cvt_pk_bf16_f32 v227, v230, v231
  s_waitcnt lgkmcnt(13)
  s_nop 0
  v_mfma_f32_32x32x16_bf16 v[96:111], a[196:199], v[224:227], v[96:111]
  v_add_u32 v33, 0x10000, v33
  v_add_u32 v34, 0x10000, v34
  v_add_u32 v35, 0x10000, v35
  v_add_u32 v36, 0x10000, v36
  ds_read_b64_tr_b16 a[208:209], v33 offset:0
  v_cvt_pk_bf16_f32 v232, v232, v233
  v_cvt_pk_bf16_f32 v233, v234, v235
  v_cvt_pk_bf16_f32 v234, v236, v237
  v_cvt_pk_bf16_f32 v235, v238, v239
  s_lshl_b32 s9, s48, 12
  s_add_u32 s67, s9, 98304
  v_mfma_f32_32x32x16_bf16 v[64:79], a[192:195], v[224:227], v[64:79]
  ds_read_b64_tr_b16 a[210:211], v33 offset:2048
  ds_read_b64_tr_b16 a[212:213], v35 offset:0
  ds_read_b64_tr_b16 a[214:215], v35 offset:2048
  ds_read_b64_tr_b16 a[112:113], v34 offset:0
  ds_read_b64_tr_b16 a[114:115], v34 offset:2048
  ds_read_b64_tr_b16 a[116:117], v36 offset:0
  ds_read_b64_tr_b16 a[118:119], v36 offset:2048
  s_xor_b32 s9, s9, 8192
  s_add_u32 s8, s9, 98304
  v_add_u32 v4, s67, v1
  v_add_u32 v5, s8, v1
  v_add_u32 v60, 0x4000, v4
  v_add_u32 v61, 0x4000, v5
  s_waitcnt lgkmcnt(12)
  v_mfma_f32_32x32x16_bf16 v[96:111], a[204:207], v[232:235], v[96:111]
  ds_read_b64_tr_b16 a[216:217], v33 offset:4096
  ds_read_b64_tr_b16 a[218:219], v33 offset:6144
  ds_read_b64_tr_b16 a[220:221], v35 offset:4096
  v_cvt_pk_bf16_f32 v240, v240, v241
  v_cvt_pk_bf16_f32 v241, v242, v243
  v_cvt_pk_bf16_f32 v242, v244, v245
  v_cvt_pk_bf16_f32 v243, v246, v247
  s_lshl_b32 s67, s61, 2
  s_add_u32 s67, s67, s55
  s_lshl_b32 s67, s67, 1
  s_add_u32 s67, s67, s56
  s_lshl_b32 s67, s67, 2
  s_add_u32 s67, s67, s48
  s_lshl_b32 s6, s67, 12
  s_add_u32 s6, s6, 16777216
  s_lshl_b32 s7, s67, 9
  s_add_u32 s7, s7, 20971520
  s_xor_b32 s67, s6, 16384
  s_xor_b32 s9, s7, 2048
  s_movk_i32 s8, 0xff
  s_sub_u32 s6, s6, 16777216
  v_mfma_f32_32x32x16_bf16 v[64:79], a[200:203], v[232:235], v[64:79]
  ds_read_b64_tr_b16 a[222:223], v35 offset:6144
  ds_read_b64_tr_b16 a[120:121], v34 offset:4096
  ds_read_b64_tr_b16 a[122:123], v34 offset:6144
  ds_read_b64_tr_b16 a[124:125], v36 offset:4096
  ds_read_b64_tr_b16 a[126:127], v36 offset:6144
  s_lshr_b32 s6, s6, 1
  s_add_u32 s6, s6, 16777216
  s_xor_b32 s67, s6, 8192
  s_add_u32 s20, s14, 1
  s_mul_i32 s20, s20, 2654435761
  s_add_u32 s21, s14, 2
  s_mul_i32 s21, s21, 2654435761
  s_add_u32 s22, s14, 3
  s_mul_i32 s22, s22, 2654435761
  s_add_u32 s23, s14, 4
  s_mul_i32 s23, s23, 2654435761
  s_add_u32 s24, s14, 5
  s_mul_i32 s24, s24, 2654435761
  s_add_u32 s25, s14, 6
  s_mul_i32 s25, s25, 2654435761
  s_add_u32 s26, s14, 7
  s_mul_i32 s26, s26, 2654435761
  s_add_u32 s27, s14, 8
  s_mul_i32 s27, s27, 2654435761
  s_waitcnt lgkmcnt(12)
  v_mfma_f32_32x32x16_bf16 v[96:111], a[212:215], v[240:243], v[96:111]
  v_cvt_pk_bf16_f32 v248, v248, v249
  v_cvt_pk_bf16_f32 v249, v250, v251
  v_mfma_f32_32x32x16_bf16 v[64:79], a[208:211], v[240:243], v[64:79]
  v_cvt_pk_bf16_f32 v250, v252, v253
  v_cvt_pk_bf16_f32 v251, v254, v255
  s_waitcnt lgkmcnt(4)
  s_nop 0
  v_mfma_f32_32x32x16_bf16 v[96:111], a[220:223], v[248:251], v[96:111]
  v_mfma_f32_32x32x16_bf16 v[64:79], a[216:219], v[248:251], v[64:79]
  v_mfma_f32_32x32x16_bf16 v[112:127], a[4:7], v[128:131], 0
  s_nop 9
  ds_write_b128 v4, v[96:99] offset:0
  v_mfma_f32_32x32x16_bf16 v[112:127], a[12:15], v[136:139], v[112:127]
  ds_write_b128 v4, v[100:103] offset:1024
  v_mfma_f32_32x32x16_bf16 v[112:127], a[20:23], v[144:147], v[112:127]
  ds_write_b128 v4, v[104:107] offset:2048
  ds_write_b128 v4, v[108:111] offset:3072
  v_mfma_f32_32x32x16_bf16 v[112:127], a[28:31], v[152:155], v[112:127]
  v_mfma_f32_32x32x16_bf16 v[112:127], a[36:39], v[160:163], v[112:127]
  s_waitcnt lgkmcnt(0)
  s_barrier
  v_mfma_f32_32x32x16_bf16 v[112:127], a[44:47], v[168:171], v[112:127]
  ds_read_b64 v[62:63], v2
  ds_read_b128 v[132:135], v5 offset:0
  ds_read_b128 v[140:143], v5 offset:1024
  ds_read_b128 v[148:151], v5 offset:2048
  ds_read_b128 v[156:159], v5 offset:3072
  v_mfma_f32_32x32x16_bf16 v[112:127], a[52:55], v[176:179], v[112:127]
  s_waitcnt lgkmcnt(4)
  v_max_f32 v39, v37, v62
  v_sub_f32 v48, v37, v39
  v_sub_f32 v50, v62, v39
  v_exp_f32 v48, v48
  v_exp_f32 v50, v50
  v_mul_f32 v38, v48, v38
  v_mfma_f32_32x32x16_bf16 v[112:127], a[60:63], v[184:187], v[112:127]
  v_fmac_f32 v38, v50, v63
  v_rcp_f32 v62, v38
  v_log_f32 v38, v38
  v_mul_f32 v48, v48, v62
  v_mul_f32 v50, v50, v62
  v_mfma_f32_32x32x16_bf16 v[112:127], a[68:71], v[192:195], v[112:127]
  v_add_f32 v38, v38, v39
  v_mov_b32 v39, s14
  v_lshlrev_b32 v6, 3, v0
  v_xad_u32 v39, v38, s14, v39
  v_mul_f32 v64, v48, v64
  v_mul_f32 v65, v48, v65
  v_mfma_f32_32x32x16_bf16 v[112:127], a[76:79], v[200:203], v[112:127]
  v_mul_f32 v66, v48, v66
  v_mul_f32 v67, v48, v67
  s_waitcnt lgkmcnt(3)
  v_fmac_f32 v64, v50, v132
  v_fmac_f32 v65, v50, v133
  v_fmac_f32 v66, v50, v134
  v_fmac_f32 v67, v50, v135
  v_mfma_f32_32x32x16_bf16 v[112:127], a[84:87], v[208:211], v[112:127]
  v_cvt_pk_bf16_f32 v64, v64, v65
  v_cvt_pk_bf16_f32 v65, v66, v67
  v_alignbit_b32 v39, v39, v39, 27
  v_xad_u32 v39, v64, s20, v39
  v_alignbit_b32 v39, v39, v39, 27
  v_mfma_f32_32x32x16_bf16 v[112:127], a[92:95], v[216:219], v[112:127]
  v_xad_u32 v39, v65, s21, v39
  v_mul_f32 v68, v48, v68
  v_mul_f32 v69, v48, v69
  v_mul_f32 v70, v48, v70
  v_mul_f32 v71, v48, v71
  s_waitcnt lgkmcnt(2)
  v_fmac_f32 v68, v50, v140
  v_mfma_f32_32x32x16_bf16 v[112:127], a[100:103], v[224:227], v[112:127]
  v_fmac_f32 v69, v50, v141
  v_fmac_f32 v70, v50, v142
  v_fmac_f32 v71, v50, v143
  v_cvt_pk_bf16_f32 v66, v68, v69
  v_cvt_pk_bf16_f32 v67, v70, v71
  v_alignbit_b32 v39, v39, v39, 27
  v_mfma_f32_32x32x16_bf16 v[112:127], a[108:111], v[232:235], v[112:127]
  v_xad_u32 v39, v66, s22, v39
  v_alignbit_b32 v39, v39, v39, 27
  v_xad_u32 v39, v67, s23, v39
  buffer_store_dwordx4 v[64:67], v1, s[44:47], s67 offen offset:0 sc1
  v_mul_f32 v72, v48, v72
  v_mfma_f32_32x32x16_bf16 v[112:127], a[116:119], v[240:243], v[112:127]
  v_mul_f32 v73, v48, v73
  v_mul_f32 v74, v48, v74
  v_mul_f32 v75, v48, v75
  s_waitcnt lgkmcnt(1)
  v_fmac_f32 v72, v50, v148
  v_fmac_f32 v73, v50, v149
  v_fmac_f32 v74, v50, v150
  v_mfma_f32_32x32x16_bf16 v[112:127], a[124:127], v[248:251], v[112:127]
  v_fmac_f32 v75, v50, v151
  v_cvt_pk_bf16_f32 v68, v72, v73
  v_cvt_pk_bf16_f32 v69, v74, v75
  v_alignbit_b32 v39, v39, v39, 27
  v_xad_u32 v39, v68, s24, v39
  v_alignbit_b32 v39, v39, v39, 27
  v_mfma_f32_32x32x16_bf16 v[80:95], a[0:3], v[128:131], 0
  v_xad_u32 v39, v69, s25, v39
  v_mul_f32 v76, v48, v76
  v_mul_f32 v77, v48, v77
  v_mul_f32 v78, v48, v78
  v_mul_f32 v79, v48, v79
  v_mfma_f32_32x32x16_bf16 v[80:95], a[8:11], v[136:139], v[80:95]
  s_waitcnt lgkmcnt(0)
  v_fmac_f32 v76, v50, v156
  v_fmac_f32 v77, v50, v157
  v_fmac_f32 v78, v50, v158
  v_fmac_f32 v79, v50, v159
  v_cvt_pk_bf16_f32 v70, v76, v77
  v_cvt_pk_bf16_f32 v71, v78, v79
  v_mfma_f32_32x32x16_bf16 v[80:95], a[16:19], v[144:147], v[80:95]
  v_alignbit_b32 v39, v39, v39, 27
  v_xad_u32 v39, v70, s26, v39
  v_alignbit_b32 v39, v39, v39, 27
  v_xad_u32 v39, v71, s27, v39
  buffer_store_dwordx4 v[68:71], v1, s[44:47], s67 offen offset:1024 sc1
  buffer_store_dwordx2 v[38:39], v6, s[44:47], s9 offen sc1
  v_mfma_f32_32x32x16_bf16 v[80:95], a[24:27], v[152:155], v[80:95]
  v_mul_f32 v112, v48, v112
  v_mfma_f32_32x32x16_bf16 v[80:95], a[32:35], v[160:163], v[80:95]
  v_mul_f32 v113, v48, v113
  v_mul_f32 v114, v48, v114
  v_mfma_f32_32x32x16_bf16 v[80:95], a[40:43], v[168:171], v[80:95]
  v_mul_f32 v115, v48, v115
  ds_write_b128 v60, v[112:115] offset:0
  v_mfma_f32_32x32x16_bf16 v[80:95], a[48:51], v[176:179], v[80:95]
  v_mul_f32 v116, v48, v116
  v_mul_f32 v117, v48, v117
  v_mfma_f32_32x32x16_bf16 v[80:95], a[56:59], v[184:187], v[80:95]
  v_mul_f32 v118, v48, v118
  v_mul_f32 v119, v48, v119
  v_mfma_f32_32x32x16_bf16 v[80:95], a[64:67], v[192:195], v[80:95]
  ds_write_b128 v60, v[116:119] offset:1024
  v_mfma_f32_32x32x16_bf16 v[80:95], a[72:75], v[200:203], v[80:95]
  v_mul_f32 v120, v48, v120
  v_mul_f32 v121, v48, v121
  v_mfma_f32_32x32x16_bf16 v[80:95], a[80:83], v[208:211], v[80:95]
  v_mul_f32 v122, v48, v122
  v_mul_f32 v123, v48, v123
  v_mfma_f32_32x32x16_bf16 v[80:95], a[88:91], v[216:219], v[80:95]
  ds_write_b128 v60, v[120:123] offset:2048
  v_mul_f32 v124, v48, v124
  v_mfma_f32_32x32x16_bf16 v[80:95], a[96:99], v[224:227], v[80:95]
  v_mul_f32 v125, v48, v125
  v_mul_f32 v126, v48, v126
  v_mfma_f32_32x32x16_bf16 v[80:95], a[104:107], v[232:235], v[80:95]
  v_mul_f32 v127, v48, v127
  ds_write_b128 v60, v[124:127] offset:3072
  v_mfma_f32_32x32x16_bf16 v[80:95], a[112:115], v[240:243], v[80:95]
  v_mfma_f32_32x32x16_bf16 v[80:95], a[120:123], v[248:251], v[80:95]
  s_waitcnt lgkmcnt(0)
  s_barrier
  ds_read_b128 v[144:147], v61 offset:0
  ds_read_b128 v[148:151], v61 offset:1024
  ds_read_b128 v[152:155], v61 offset:2048
  ds_read_b128 v[156:159], v61 offset:3072
  s_waitcnt lgkmcnt(3)
  s_nop 4
  v_pk_fma_f32 v[80:81], v[80:81], v[48:49], v[144:145] op_sel_hi:[1,0,1]
  v_pk_fma_f32 v[82:83], v[82:83], v[48:49], v[146:147] op_sel_hi:[1,0,1]
  s_waitcnt lgkmcnt(2)
  v_pk_fma_f32 v[84:85], v[84:85], v[48:49], v[148:149] op_sel_hi:[1,0,1]
  v_pk_fma_f32 v[86:87], v[86:87], v[48:49], v[150:151] op_sel_hi:[1,0,1]
  s_waitcnt lgkmcnt(1)
  v_pk_fma_f32 v[88:89], v[88:89], v[48:49], v[152:153] op_sel_hi:[1,0,1]
  v_pk_fma_f32 v[90:91], v[90:91], v[48:49], v[154:155] op_sel_hi:[1,0,1]
  s_waitcnt lgkmcnt(0)
  v_pk_fma_f32 v[92:93], v[92:93], v[48:49], v[156:157] op_sel_hi:[1,0,1]
  v_pk_fma_f32 v[94:95], v[94:95], v[48:49], v[158:159] op_sel_hi:[1,0,1]
  s_lshl_b32 s67, s61, 2
  s_add_u32 s67, s67, s55
  s_lshl_b32 s67, s67, 5
  s_lshl_b32 s8, s56, 2
  s_add_u32 s67, s67, s8
  s_add_u32 s67, s67, s48
  s_lshl_b32 s67, s67, 2
  s_add_u32 s9, s67, 10682368
  s_lshl_b32 s67, s61, 2
  s_add_u32 s67, s67, s55
  s_lshl_b32 s67, s67, 1
  s_add_u32 s67, s67, s56
  s_lshl_b32 s67, s67, 2
  s_add_u32 s67, s67, s48
  s_lshl_b32 s67, s67, 7
  s_add_u32 s9, s67, 22020096
  s_add_u32 m0, s16, 0
  s_xor_b32 s11, s65, 131072
  buffer_load_dwordx4 v17, s[36:39], s11 offen  lds
  buffer_load_dwordx4 v18, s[36:39], s11 offen offset:1024  lds
  buffer_load_dwordx4 v19, s[36:39], s11 offen offset:2048  lds
  buffer_load_dwordx4 v20, s[36:39], s11 offen offset:3072  lds
  s_add_u32 m0, s16, 16384
  s_xor_b32 s11, s65, 196608
  buffer_load_dwordx4 v17, s[36:39], s11 offen  lds
  buffer_load_dwordx4 v18, s[36:39], s11 offen offset:1024  lds
  buffer_load_dwordx4 v19, s[36:39], s11 offen offset:2048  lds
  buffer_load_dwordx4 v20, s[36:39], s11 offen offset:3072  lds
  s_lshl_b32 s5, s52, 3
  s_add_u32 s5, s5, s51
  s_lshl_b32 s17, s5, 2
  s_add_u32 s17, s17, s48
  s_lshl_b32 s17, s17, 10
  s_add_u32 s19, s17, 22020096
  s_xor_b32 s5, s15, 0x5a5a5a5a
  s_bfe_u32 s17, s5, 524288
  v_mov_b32 v56, s17
  s_bfe_u32 s17, s5, 524296
  v_mov_b32 v57, s17
  s_bfe_u32 s17, s5, 524304
  v_mov_b32 v58, s17
  s_bfe_u32 s17, s5, 524312
  v_mov_b32 v59, s17
  s_xor_b32 s5, s59, 0x5a5a5a5a
  s_bfe_u32 s17, s5, 524288
  v_mov_b32 v60, s17
  s_bfe_u32 s17, s5, 524296
  v_mov_b32 v61, s17
  s_bfe_u32 s17, s5, 524304
  v_mov_b32 v62, s17
  s_bfe_u32 s17, s5, 524312
  v_mov_b32 v63, s17
  s_xor_b32 s62, s13, 0x5a5a5a5a
  v_and_b32 v7, 7, v0
  v_lshlrev_b32 v7, 7, v7
  v_and_b32 v4, 31, v0
  v_lshrrev_b32 v5, 5, v0
  v_and_b32 v28, 7, v0
  v_xor_b32 v5, v5, v28
  v_lshlrev_b32 v5, 4, v5
  v_lshl_add_u32 v5, v4, 8, v5
  s_lshl_b32 s17, s48, 13
  v_add_u32 v176, s17, v5
  v_xor_b32 v177, 32, v176
  v_xor_b32 v178, 64, v176
  v_xor_b32 v179, 96, v176
  v_xor_b32 v180, 128, v176
  v_xor_b32 v181, 160, v176
  v_xor_b32 v182, 192, v176
  v_xor_b32 v183, 224, v176
  v_lshrrev_b32 v4, 4, v0
  v_and_b32 v5, 15, v0
  v_xor_b32 v28, v5, v4
  v_lshlrev_b32 v28, 4, v28
  v_lshl_add_u32 v28, v4, 8, v28
  s_lshl_b32 s17, s48, 11
  v_add_u32 v184, s17, v28
  v_xor_b32 v185, 64, v184
  s_lshl_b32 s4, s58, 6
  v_xor_b32 v186, s4, v28
  s_lshl_b32 s17, s58, 10
  s_lshl_b32 s4, s51, 11
  s_add_u32 s17, s17, s4
  v_add_u32 v186, s17, v186
  v_lshlrev_b32 v5, 3, v5
  v_lshl_add_u32 v187, v4, 11, v5
  s_lshl_b32 s33, s52, 5
  s_add_u32 s33, s33, s60
  s_lshl_b32 s33, s33, 15
  s_add_u32 s33, s33, 6291456
  s_lshl_b32 s34, s48, 13
  s_lshl_b32 s4, s51, 11
  s_add_u32 s34, s34, s4
  s_add_u32 s34, s34, s33
  s_lshl_b32 s4, s51, 13
  s_add_u32 s33, s33, s4
  s_lshl_b32 s4, s58, 10
  s_add_u32 s33, s33, s4
  s_lshl_b32 s4, s57, 19
  s_add_u32 s33, s33, s4
  s_xor_b32 s4, s51, 1
  s_lshl_b32 s4, s4, 11
  s_add_u32 s28, s33, s4
  s_xor_b32 s4, s51, 2
  s_lshl_b32 s4, s4, 11
  s_add_u32 s29, s33, s4
  s_xor_b32 s4, s51, 3
  s_lshl_b32 s4, s4, 11
  s_add_u32 s30, s33, s4
  s_lshl_b32 s31, s52, 1
  s_add_u32 s31, s31, s57
  s_lshl_b32 s31, s31, 16
  s_lshl_b32 s4, s51, 14
  s_add_u32 s31, s31, s4
  s_lshl_b32 s4, s58, 13
  s_add_u32 s31, s31, s4
  s_lshl_b32 s4, s60, 7
  s_add_u32 s31, s31, s4
  s_movk_i32 s35, 0xff
  s_mov_b32 s32, 0x0c0c0400
  s_and_b32 s4, s62, 0xffff
  v_mov_b32 v26, s4
  s_lshr_b32 s4, s62, 16
  v_mov_b32 v27, s4
  s_add_u32 s33, s34, 524288
  s_add_u32 s63, s19, 16384
  buffer_load_dwordx2 v[50:51], v6, s[44:47], s7 offen sc1
  buffer_load_dwordx4 v[144:147], v1, s[44:47], s6 offen offset:0 sc1
  buffer_load_dwordx4 v[148:151], v1, s[44:47], s6 offen offset:1024 sc1
  v_add_u32 v21, 0x10000, v21
  v_add_u32 v22, 0x10000, v22
  s_add_u32 m0, s16, 32768
  s_xor_b32 s11, s65, 262144
  buffer_load_dwordx4 v17, s[36:39], s11 offen  lds
  s_waitcnt vmcnt(19)
  ds_read_b64_tr_b16 a[128:129], v21 offset:16384
  ds_read_b64_tr_b16 a[130:131], v21 offset:17408
  ds_read_b64_tr_b16 a[132:133], v22 offset:16384
  buffer_load_dwordx4 v18, s[36:39], s11 offen offset:1024  lds
  ds_read_b64_tr_b16 a[134:135], v22 offset:17408
  ds_read_b64_tr_b16 a[136:137], v21 offset:18432
  ds_read_b64_tr_b16 a[138:139], v21 offset:19456
  buffer_load_dwordx4 v19, s[36:39], s11 offen offset:2048  lds
  ds_read_b64_tr_b16 a[140:141], v22 offset:18432
  ds_read_b64_tr_b16 a[142:143], v22 offset:19456
  buffer_load_dwordx4 v20, s[36:39], s11 offen offset:3072  lds
  v_add_u32 v21, 0x10000, v21
  v_add_u32 v22, 0x10000, v22
  s_waitcnt vmcnt(18)
  ds_read_b64_tr_b16 a[144:145], v21 offset:0
  ds_read_b64_tr_b16 a[146:147], v21 offset:1024
  ds_read_b64_tr_b16 a[148:149], v22 offset:0
  ds_read_b64_tr_b16 a[150:151], v22 offset:1024
  ds_read_b64_tr_b16 a[152:153], v21 offset:2048
  ds_read_b64_tr_b16 a[154:155], v21 offset:3072
  ds_read_b64_tr_b16 a[156:157], v22 offset:2048
  ds_read_b64_tr_b16 a[158:159], v22 offset:3072
  s_add_u32 m0, s16, 49152
  s_xor_b32 s11, s65, 327680
  buffer_load_dwordx4 v17, s[36:39], s11 offen  lds
  buffer_load_dwordx4 v18, s[36:39], s11 offen offset:1024  lds
  buffer_load_dwordx4 v19, s[36:39], s11 offen offset:2048  lds
  buffer_load_dwordx4 v20, s[36:39], s11 offen offset:3072  lds
  s_mov_b32 s12, 0x100000
  s_mov_b32 s4, 0x0c0c0400
  s_and_b32 s5, s14, 0xffff
  v_mov_b32 v48, s5
  s_lshr_b32 s5, s14, 16
  v_mov_b32 v49, s5
  s_lshl_b32 s67, s61, 2
  s_add_u32 s67, s67, s55
  s_lshl_b32 s67, s67, 1
  s_add_u32 s67, s67, s58
  s_lshl_b32 s67, s67, 1
  s_add_u32 s67, s67, s57
  s_lshl_b32 s67, s67, 1
  s_add_u32 s67, s67, s56
  s_lshl_b32 s67, s67, 11
  s_add_u32 s67, s67, 2097152
  s_waitcnt vmcnt(8)
  s_branch L_x_chk
L_x:
  buffer_load_dwordx2 v[50:51], v6, s[44:47], s7 offen sc1
  buffer_load_dwordx4 v[144:147], v1, s[44:47], s6 offen offset:0 sc1
  buffer_load_dwordx4 v[148:151], v1, s[44:47], s6 offen offset:1024 sc1
  s_waitcnt vmcnt(0)
L_x_chk:
  v_mov_b32 v39, s14
  v_xad_u32 v39, v50, s14, v39
  v_sub_f32 v50, v50, v38
  v_alignbit_b32 v39, v39, v39, 27
  v_xad_u32 v39, v144, s20, v39
  v_alignbit_b32 v39, v39, v39, 27
  v_xad_u32 v39, v145, s21, v39
  v_exp_f32 v50, v50
  v_alignbit_b32 v39, v39, v39, 27
  v_xad_u32 v39, v146, s22, v39
  v_alignbit_b32 v39, v39, v39, 27
  v_xad_u32 v39, v147, s23, v39
  v_alignbit_b32 v39, v39, v39, 27
  v_xad_u32 v39, v148, s24, v39
  v_alignbit_b32 v39, v39, v39, 27
  v_xad_u32 v39, v149, s25, v39
  v_alignbit_b32 v39, v39, v39, 27
  v_xad_u32 v39, v150, s26, v39
  v_alignbit_b32 v39, v39, v39, 27
  v_xad_u32 v39, v151, s27, v39
  v_xor_b32 v39, v39, v51
  v_cmp_ne_u32 vcc, 0, v39
  v_add_f32 v50, 1.0, v50
  s_cbranch_vccz L_x_ok
  s_sub_u32 s12, s12, 1
  s_cmp_lg_u32 s12, 0
  s_cbranch_scc1 L_x
L_x_ok:
  v_rcp_f32 v50, v50
  v_lshlrev_b32 v160, 16, v144
  v_and_b32 v161, 0xffff0000, v144
  v_lshlrev_b32 v162, 16, v145
  v_and_b32 v163, 0xffff0000, v145
  v_lshlrev_b32 v164, 16, v146
  v_and_b32 v165, 0xffff0000, v146
  v_lshlrev_b32 v166, 16, v147
  v_and_b32 v167, 0xffff0000, v147
  v_lshlrev_b32 v168, 16, v148
  v_and_b32 v169, 0xffff0000, v148
  v_lshlrev_b32 v170, 16, v149
  v_and_b32 v171, 0xffff0000, v149
  v_lshlrev_b32 v172, 16, v150
  v_and_b32 v173, 0xffff0000, v150
  v_lshlrev_b32 v174, 16, v151
  v_and_b32 v175, 0xffff0000, v151
  v_pk_add_f32 v[80:81], v[80:81], v[160:161] neg_lo:[0,1] neg_hi:[0,1]
  v_pk_add_f32 v[82:83], v[82:83], v[162:163] neg_lo:[0,1] neg_hi:[0,1]
  v_pk_add_f32 v[84:85], v[84:85], v[164:165] neg_lo:[0,1] neg_hi:[0,1]
  v_pk_add_f32 v[86:87], v[86:87], v[166:167] neg_lo:[0,1] neg_hi:[0,1]
  v_pk_add_f32 v[88:89], v[88:89], v[168:169] neg_lo:[0,1] neg_hi:[0,1]
  v_pk_add_f32 v[90:91], v[90:91], v[170:171] neg_lo:[0,1] neg_hi:[0,1]
  v_pk_add_f32 v[92:93], v[92:93], v[172:173] neg_lo:[0,1] neg_hi:[0,1]
  v_pk_add_f32 v[94:95], v[94:95], v[174:175] neg_lo:[0,1] neg_hi:[0,1]
  v_pk_fma_f32 v[80:81], v[80:81], v[50:51], v[160:161] op_sel_hi:[1,0,1]
  v_pk_fma_f32 v[82:83], v[82:83], v[50:51], v[162:163] op_sel_hi:[1,0,1]
  v_pk_fma_f32 v[84:85], v[84:85], v[50:51], v[164:165] op_sel_hi:[1,0,1]
  v_pk_fma_f32 v[86:87], v[86:87], v[50:51], v[166:167] op_sel_hi:[1,0,1]
  v_cvt_pk_bf16_f32 v40, v80, v81
  v_cvt_pk_bf16_f32 v41, v82, v83
  v_cvt_pk_bf16_f32 v42, v84, v85
  v_cvt_pk_bf16_f32 v43, v86, v87
  buffer_store_dwordx4 v[40:43], v1, s[44:47], s67 offen offset:0 sc1
  v_pk_fma_f32 v[88:89], v[88:89], v[50:51], v[168:169] op_sel_hi:[1,0,1]
  v_pk_fma_f32 v[90:91], v[90:91], v[50:51], v[170:171] op_sel_hi:[1,0,1]
  v_pk_fma_f32 v[92:93], v[92:93], v[50:51], v[172:173] op_sel_hi:[1,0,1]
  v_pk_fma_f32 v[94:95], v[94:95], v[50:51], v[174:175] op_sel_hi:[1,0,1]
  v_cvt_pk_bf16_f32 v44, v88, v89
  v_cvt_pk_bf16_f32 v45, v90, v91
  v_cvt_pk_bf16_f32 v46, v92, v93
  v_cvt_pk_bf16_f32 v47, v94, v95
  buffer_store_dwordx4 v[44:47], v1, s[44:47], s67 offen offset:1024 sc1
  s_waitcnt vmcnt(0)
  s_barrier
  s_cmp_lg_u32 s48, 0
  s_cbranch_scc1 L_noflag
  v_mov_b32 v4, s14
  v_and_b32 v5, 31, v0
  v_lshlrev_b32 v5, 2, v5
  buffer_store_dword v4, v5, s[44:47], s9 offen sc1
L_noflag:
  v_add_u32 v21, 0xfffe0000, v21
  v_add_u32 v22, 0xfffe0000, v22
  s_add_u32 m0, s16, 81920
  s_xor_b32 s11, s65, 393216
  s_waitcnt lgkmcnt(8)
  buffer_load_dwordx4 v17, s[36:39], s11 offen  lds
  buffer_load_dwordx4 v18, s[36:39], s11 offen offset:1024  lds
  ds_read_b64_tr_b16 a[160:161], v21 offset:0
  ds_read_b64_tr_b16 a[162:163], v21 offset:1024
  ds_read_b64_tr_b16 a[164:165], v22 offset:0
  buffer_load_dwordx4 v19, s[36:39], s11 offen offset:2048  lds
  buffer_load_dwordx4 v20, s[36:39], s11 offen offset:3072  lds
  ds_read_b64_tr_b16 a[166:167], v22 offset:1024
  ds_read_b64_tr_b16 a[168:169], v21 offset:2048
  ds_read_b64_tr_b16 a[170:171], v21 offset:3072
  s_add_u32 m0, s16, 131072
  s_xor_b32 s11, s65, 458752
  s_waitcnt lgkmcnt(6)
  buffer_load_dwordx4 v17, s[36:39], s11 offen  lds
  buffer_load_dwordx4 v18, s[36:39], s11 offen offset:1024  lds
  ds_read_b64_tr_b16 a[172:173], v22 offset:2048
  ds_read_b64_tr_b16 a[174:175], v22 offset:3072
  buffer_load_dwordx4 v19, s[36:39], s11 offen offset:2048  lds
  buffer_load_dwordx4 v20, s[36:39], s11 offen offset:3072  lds
  s_waitcnt lgkmcnt(0)
  s_add_u32 s0, s44, s19
  s_addc_u32 s1, s45, 0
  s_load_dword s20, s[0:1], 0 glc
  s_load_dword s21, s[0:1], 512 glc
  ds_read_b64_tr_b16 a[176:177], v21 offset:16384
  ds_read_b64_tr_b16 a[178:179], v21 offset:17408
  ds_read_b64_tr_b16 a[180:181], v22 offset:16384
  ds_read_b64_tr_b16 a[182:183], v22 offset:17408
  ds_read_b64_tr_b16 a[184:185], v21 offset:18432
  ds_read_b64_tr_b16 a[186:187], v21 offset:19456
  ds_read_b64_tr_b16 a[188:189], v22 offset:18432
  ds_read_b64_tr_b16 a[190:191], v22 offset:19456
  ds_read_b64_tr_b16 a[192:193], v21 offset:32768
  ds_read_b64_tr_b16 a[194:195], v21 offset:33792
  ds_read_b64_tr_b16 a[196:197], v22 offset:32768
  ds_read_b64_tr_b16 a[198:199], v22 offset:33792
  ds_read_b64_tr_b16 a[200:201], v21 offset:34816
  ds_read_b64_tr_b16 a[202:203], v21 offset:35840
  ds_read_b64_tr_b16 a[204:205], v22 offset:34816
  ds_read_b64_tr_b16 a[206:207], v22 offset:35840
  s_mov_b32 s12, 0x200000
  s_branch L_po_chk
L_po:
  s_add_u32 s0, s44, s19
  s_addc_u32 s1, s45, 0
  s_waitcnt lgkmcnt(0)
  s_load_dword s20, s[0:1], 0 glc
  s_load_dword s21, s[0:1], 512 glc
L_po_chk:
  s_waitcnt lgkmcnt(0)
  s_xor_b32 s20, s20, s15
  s_xor_b32 s21, s21, s15
  s_or_b32 s20, s20, s21
  s_cbranch_scc0 L_po_ok
  s_sub_u32 s12, s12, 1
  s_cmp_lg_u32 s12, 0
  s_cbranch_scc1 L_po
L_po_ok:
  s_add_u32 s0, s44, s63
  s_addc_u32 s1, s45, 0
  s_load_dword s20, s[0:1], 0 glc
  s_load_dword s21, s[0:1], 512 glc
  s_xor_b32 s67, s66, 0
  buffer_load_dwordx4 v[192:195], v1, s[44:47], s67 offen sc1
  s_xor_b32 s67, s66, 1024
  buffer_load_dwordx4 v[196:199], v1, s[44:47], s67 offen sc1
  s_xor_b32 s67, s66, 2048
  buffer_load_dwordx4 v[200:203], v1, s[44:47], s67 offen sc1
  s_xor_b32 s67, s66, 3072
  buffer_load_dwordx4 v[204:207], v1, s[44:47], s67 offen sc1
  s_xor_b32 s67, s66, 4096
  buffer_load_dwordx4 v[208:211], v1, s[44:47], s67 offen sc1
  s_xor_b32 s67, s66, 5120
  buffer_load_dwordx4 v[212:215], v1, s[44:47], s67 offen sc1
  s_xor_b32 s67, s66, 6144
  buffer_load_dwordx4 v[216:219], v1, s[44:47], s67 offen sc1
  s_xor_b32 s67, s66, 7168
  buffer_load_dwordx4 v[220:223], v1, s[44:47], s67 offen sc1
  s_waitcnt vmcnt(7)
  v_mfma_f32_32x32x16_bf16 v[64:79], a[128:131], v[192:195], 0
  s_xor_b32 s67, s66, 8192
  buffer_load_dwordx4 v[224:227], v1, s[44:47], s67 offen sc1
  v_mfma_f32_32x32x16_bf16 v[80:95], a[132:135], v[192:195], 0
  s_xor_b32 s67, s66, 9216
  buffer_load_dwordx4 v[228:231], v1, s[44:47], s67 offen sc1
  s_waitcnt vmcnt(8)
  v_mfma_f32_32x32x16_bf16 v[64:79], a[136:139], v[196:199], v[64:79]
  s_xor_b32 s67, s66, 10240
  buffer_load_dwordx4 v[232:235], v1, s[44:47], s67 offen sc1
  v_mfma_f32_32x32x16_bf16 v[80:95], a[140:143], v[196:199], v[80:95]
  s_xor_b32 s67, s66, 11264
  buffer_load_dwordx4 v[236:239], v1, s[44:47], s67 offen sc1
  s_waitcnt vmcnt(9)
  v_mfma_f32_32x32x16_bf16 v[64:79], a[144:147], v[200:203], v[64:79]
  s_xor_b32 s67, s66, 12288
  buffer_load_dwordx4 v[240:243], v1, s[44:47], s67 offen sc1
  v_mfma_f32_32x32x16_bf16 v[80:95], a[148:151], v[200:203], v[80:95]
  s_xor_b32 s67, s66, 13312
  buffer_load_dwordx4 v[244:247], v1, s[44:47], s67 offen sc1
  s_waitcnt vmcnt(10)
  v_mfma_f32_32x32x16_bf16 v[64:79], a[152:155], v[204:207], v[64:79]
  s_xor_b32 s67, s66, 14336
  buffer_load_dwordx4 v[248:251], v1, s[44:47], s67 offen sc1
  v_mfma_f32_32x32x16_bf16 v[80:95], a[156:159], v[204:207], v[80:95]
  s_xor_b32 s67, s66, 15360
  buffer_load_dwordx4 v[252:255], v1, s[44:47], s67 offen sc1
  s_mov_b32 s12, 0x200000
  s_branch L_pb_chk
L_pb:
  s_add_u32 s0, s44, s63
  s_addc_u32 s1, s45, 0
  s_waitcnt lgkmcnt(0)
  s_load_dword s20, s[0:1], 0 glc
  s_load_dword s21, s[0:1], 512 glc
L_pb_chk:
  s_waitcnt lgkmcnt(0)
  s_xor_b32 s20, s20, s59
  s_xor_b32 s21, s21, s59
  s_or_b32 s20, s20, s21
  s_cbranch_scc0 L_pb_ok
  s_sub_u32 s12, s12, 1
  s_cmp_lg_u32 s12, 0
  s_cbranch_scc1 L_pb
L_pb_ok:
  s_waitcnt vmcnt(11)
  v_mfma_f32_32x32x16_bf16 v[64:79], a[160:163], v[208:211], v[64:79]
  s_xor_b32 s67, s66, 262144
  buffer_load_dwordx4 a[0:3], v1, s[44:47], s67 offen sc1
  v_mfma_f32_32x32x16_bf16 v[80:95], a[164:167], v[208:211], v[80:95]
  s_xor_b32 s67, s66, 263168
  buffer_load_dwordx4 a[4:7], v1, s[44:47], s67 offen sc1
  s_waitcnt vmcnt(12)
  v_mfma_f32_32x32x16_bf16 v[64:79], a[168:171], v[212:215], v[64:79]
  s_xor_b32 s67, s66, 264192
  buffer_load_dwordx4 a[8:11], v1, s[44:47], s67 offen sc1
  v_mfma_f32_32x32x16_bf16 v[80:95], a[172:175], v[212:215], v[80:95]
  s_xor_b32 s67, s66, 265216
  buffer_load_dwordx4 a[12:15], v1, s[44:47], s67 offen sc1
  s_waitcnt vmcnt(13)
  v_mfma_f32_32x32x16_bf16 v[64:79], a[176:179], v[216:219], v[64:79]
  s_xor_b32 s67, s66, 266240
  buffer_load_dwordx4 a[16:19], v1, s[44:47], s67 offen sc1
  v_mfma_f32_32x32x16_bf16 v[80:95], a[180:183], v[216:219], v[80:95]
  s_xor_b32 s67, s66, 267264
  buffer_load_dwordx4 a[20:23], v1, s[44:47], s67 offen sc1
  s_waitcnt vmcnt(14)
  v_mfma_f32_32x32x16_bf16 v[64:79], a[184:187], v[220:223], v[64:79]
  s_xor_b32 s67, s66, 268288
  buffer_load_dwordx4 a[24:27], v1, s[44:47], s67 offen sc1
  v_mfma_f32_32x32x16_bf16 v[80:95], a[188:191], v[220:223], v[80:95]
  s_xor_b32 s67, s66, 269312
  buffer_load_dwordx4 a[28:31], v1, s[44:47], s67 offen sc1
  s_waitcnt vmcnt(15)
  v_mfma_f32_32x32x16_bf16 v[64:79], a[192:195], v[224:227], v[64:79]
  s_xor_b32 s67, s66, 270336
  buffer_load_dwordx4 a[32:35], v1, s[44:47], s67 offen sc1
  ds_read_b64_tr_b16 a[208:209], v21 offset:49152
  ds_read_b64_tr_b16 a[210:211], v21 offset:50176
  ds_read_b64_tr_b16 a[212:213], v22 offset:49152
  ds_read_b64_tr_b16 a[214:215], v22 offset:50176
  v_mfma_f32_32x32x16_bf16 v[80:95], a[196:199], v[224:227], v[80:95]
  s_xor_b32 s67, s66, 271360
  buffer_load_dwordx4 a[36:39], v1, s[44:47], s67 offen sc1
  ds_read_b64_tr_b16 a[216:217], v21 offset:51200
  ds_read_b64_tr_b16 a[218:219], v21 offset:52224
  ds_read_b64_tr_b16 a[220:221], v22 offset:51200
  ds_read_b64_tr_b16 a[222:223], v22 offset:52224
  s_waitcnt vmcnt(16)
  v_mfma_f32_32x32x16_bf16 v[64:79], a[200:203], v[228:231], v[64:79]
  s_xor_b32 s67, s66, 272384
  buffer_load_dwordx4 a[40:43], v1, s[44:47], s67 offen sc1
  v_mfma_f32_32x32x16_bf16 v[80:95], a[204:207], v[228:231], v[80:95]
  s_xor_b32 s67, s66, 273408
  buffer_load_dwordx4 a[44:47], v1, s[44:47], s67 offen sc1
  s_waitcnt vmcnt(17) lgkmcnt(6)
  v_mfma_f32_32x32x16_bf16 v[64:79], a[208:211], v[232:235], v[64:79]
  s_xor_b32 s67, s66, 274432
  buffer_load_dwordx4 a[48:51], v1, s[44:47], s67 offen sc1
  v_add_u32 v21, 0x10000, v21
  v_add_u32 v22, 0x10000, v22
  ds_read_b64_tr_b16 a[224:225], v21 offset:16384
  ds_read_b64_tr_b16 a[226:227], v21 offset:17408
  ds_read_b64_tr_b16 a[228:229], v22 offset:16384
  s_waitcnt lgkmcnt(7)
  v_mfma_f32_32x32x16_bf16 v[80:95], a[212:215], v[232:235], v[80:95]
  s_xor_b32 s67, s66, 275456
  buffer_load_dwordx4 a[52:55], v1, s[44:47], s67 offen sc1
  ds_read_b64_tr_b16 a[230:231], v22 offset:17408
  ds_read_b64_tr_b16 a[232:233], v21 offset:18432
  ds_read_b64_tr_b16 a[234:235], v21 offset:19456
  ds_read_b64_tr_b16 a[236:237], v22 offset:18432
  ds_read_b64_tr_b16 a[238:239], v22 offset:19456
  s_waitcnt vmcnt(18) lgkmcnt(10)
  v_mfma_f32_32x32x16_bf16 v[64:79], a[216:219], v[236:239], v[64:79]
  s_xor_b32 s67, s66, 276480
  buffer_load_dwordx4 a[56:59], v1, s[44:47], s67 offen sc1
  s_waitcnt lgkmcnt(8)
  v_mfma_f32_32x32x16_bf16 v[80:95], a[220:223], v[236:239], v[80:95]
  s_xor_b32 s67, s66, 277504
  buffer_load_dwordx4 a[60:63], v1, s[44:47], s67 offen sc1
  s_waitcnt vmcnt(19) lgkmcnt(6)
  v_mfma_f32_32x32x16_bf16 v[64:79], a[224:227], v[240:243], v[64:79]
  v_add_u32 v21, 0x10000, v21
  v_add_u32 v22, 0x10000, v22
  ds_read_b64_tr_b16 a[240:241], v21 offset:0
  ds_read_b64_tr_b16 a[242:243], v21 offset:1024
  ds_read_b64_tr_b16 a[244:245], v22 offset:0
  s_waitcnt lgkmcnt(7)
  v_mfma_f32_32x32x16_bf16 v[80:95], a[228:231], v[240:243], v[80:95]
  ds_read_b64_tr_b16 a[246:247], v22 offset:1024
  ds_read_b64_tr_b16 a[248:249], v21 offset:2048
  ds_read_b64_tr_b16 a[250:251], v21 offset:3072
  ds_read_b64_tr_b16 a[252:253], v22 offset:2048
  ds_read_b64_tr_b16 a[254:255], v22 offset:3072
  s_waitcnt vmcnt(18) lgkmcnt(10)
  v_mfma_f32_32x32x16_bf16 v[64:79], a[232:235], v[244:247], v[64:79]
  s_waitcnt lgkmcnt(8)
  v_mfma_f32_32x32x16_bf16 v[80:95], a[236:239], v[244:247], v[80:95]
  s_waitcnt vmcnt(17) lgkmcnt(6)
  v_mfma_f32_32x32x16_bf16 v[64:79], a[240:243], v[248:251], v[64:79]
  s_waitcnt lgkmcnt(4)
  v_mfma_f32_32x32x16_bf16 v[80:95], a[244:247], v[248:251], v[80:95]
  s_waitcnt vmcnt(16) lgkmcnt(2)
  v_mfma_f32_32x32x16_bf16 v[64:79], a[248:251], v[252:255], v[64:79]
  s_waitcnt lgkmcnt(0)
  v_mfma_f32_32x32x16_bf16 v[80:95], a[252:255], v[252:255], v[80:95]
  s_mov_b32 s12, 0x100000
  s_barrier
  s_waitcnt vmcnt(15)
  v_mfma_f32_32x32x16_bf16 v[96:111], a[128:131], a[0:3], 0
  s_waitcnt vmcnt(14)
  v_mfma_f32_32x32x16_bf16 v[96:111], a[136:139], a[4:7], v[96:111]
  s_nop 3
  ds_write_b128 v176, v[64:67] offset:0
  s_waitcnt vmcnt(13)
  v_mfma_f32_32x32x16_bf16 v[96:111], a[144:147], a[8:11], v[96:111]
  ds_write_b128 v177, v[68:71] offset:0
  s_waitcnt vmcnt(12)
  v_mfma_f32_32x32x16_bf16 v[96:111], a[152:155], a[12:15], v[96:111]
  s_waitcnt vmcnt(11)
  v_mfma_f32_32x32x16_bf16 v[96:111], a[160:163], a[16:19], v[96:111]
  ds_write_b128 v178, v[72:75] offset:0
  s_waitcnt vmcnt(10)
  v_mfma_f32_32x32x16_bf16 v[96:111], a[168:171], a[20:23], v[96:111]
  ds_write_b128 v179, v[76:79] offset:0
  s_waitcnt vmcnt(9)
  v_mfma_f32_32x32x16_bf16 v[96:111], a[176:179], a[24:27], v[96:111]
  ds_write_b128 v180, v[80:83] offset:0
  s_waitcnt vmcnt(8)
  v_mfma_f32_32x32x16_bf16 v[96:111], a[184:187], a[28:31], v[96:111]
  s_waitcnt vmcnt(7)
  v_mfma_f32_32x32x16_bf16 v[96:111], a[192:195], a[32:35], v[96:111]
  ds_write_b128 v181, v[84:87] offset:0
  s_waitcnt vmcnt(6)
  v_mfma_f32_32x32x16_bf16 v[96:111], a[200:203], a[36:39], v[96:111]
  ds_write_b128 v182, v[88:91] offset:0
  s_waitcnt vmcnt(5)
  v_mfma_f32_32x32x16_bf16 v[96:111], a[208:211], a[40:43], v[96:111]
  ds_write_b128 v183, v[92:95] offset:0
  s_waitcnt vmcnt(4)
  v_mfma_f32_32x32x16_bf16 v[96:111], a[216:219], a[44:47], v[96:111]
  s_waitcnt vmcnt(3)
  v_mfma_f32_32x32x16_bf16 v[96:111], a[224:227], a[48:51], v[96:111]
  s_waitcnt lgkmcnt(0)
  s_barrier
  s_waitcnt vmcnt(2)
  v_mfma_f32_32x32x16_bf16 v[96:111], a[232:235], a[52:55], v[96:111]
  ds_read_b128 v[128:131], v184 offset:0
  ds_read_b128 v[132:135], v184 offset:8192
  ds_read_b128 v[136:139], v184 offset:16384
  s_waitcnt vmcnt(1)
  v_mfma_f32_32x32x16_bf16 v[96:111], a[240:243], a[56:59], v[96:111]
  ds_read_b128 v[140:143], v184 offset:24576
  ds_read_b128 v[144:147], v185 offset:1024
  ds_read_b128 v[148:151], v185 offset:9216
  s_waitcnt vmcnt(0)
  v_mfma_f32_32x32x16_bf16 v[96:111], a[248:251], a[60:63], v[96:111]
  ds_read_b128 v[152:155], v185 offset:17408
  ds_read_b128 v[156:159], v185 offset:25600
  s_cmp_lg_u32 s57, 0
  s_cbranch_scc1 L_noown0
  ds_read_b128 v[160:163], v186 offset:0
  ds_read_b128 v[164:167], v186 offset:8192
  ds_read_b128 v[168:171], v186 offset:16384
  ds_read_b128 v[172:175], v186 offset:24576
L_noown0:
  v_mfma_f32_32x32x16_bf16 v[112:127], a[132:135], a[0:3], 0
  s_waitcnt lgkmcnt(6)
  v_add_f32 v128, v128, v132
  v_add_f32 v129, v129, v133
  v_add_f32 v130, v130, v134
  v_mfma_f32_32x32x16_bf16 v[112:127], a[140:143], a[4:7], v[112:127]
  v_add_f32 v131, v131, v135
  s_waitcnt lgkmcnt(4)
  v_add_f32 v136, v136, v140
  v_add_f32 v137, v137, v141
  v_add_f32 v138, v138, v142
  v_mfma_f32_32x32x16_bf16 v[112:127], a[148:151], a[8:11], v[112:127]
  v_add_f32 v139, v139, v143
  v_add_f32 v128, v128, v136
  v_add_f32 v129, v129, v137
  v_add_f32 v130, v130, v138
  v_mfma_f32_32x32x16_bf16 v[112:127], a[156:159], a[12:15], v[112:127]
  v_add_f32 v131, v131, v139
  v_bfi_b32 v128, s35, v56, v128
  v_bfi_b32 v129, s35, v57, v129
  v_mfma_f32_32x32x16_bf16 v[112:127], a[164:167], a[16:19], v[112:127]
  v_bfi_b32 v130, s35, v58, v130
  v_bfi_b32 v131, s35, v59, v131
  s_waitcnt lgkmcnt(2)
  v_add_f32 v144, v144, v148
  v_add_f32 v145, v145, v149
  v_mfma_f32_32x32x16_bf16 v[112:127], a[172:175], a[20:23], v[112:127]
  v_add_f32 v146, v146, v150
  v_add_f32 v147, v147, v151
  s_waitcnt lgkmcnt(0)
  v_add_f32 v152, v152, v156
  v_add_f32 v153, v153, v157
  v_mfma_f32_32x32x16_bf16 v[112:127], a[180:183], a[24:27], v[112:127]
  v_add_f32 v154, v154, v158
  v_add_f32 v155, v155, v159
  v_add_f32 v144, v144, v152
  v_mfma_f32_32x32x16_bf16 v[112:127], a[188:191], a[28:31], v[112:127]
  v_add_f32 v145, v145, v153
  v_add_f32 v146, v146, v154
  v_add_f32 v147, v147, v155
  v_bfi_b32 v144, s35, v56, v144
  v_mfma_f32_32x32x16_bf16 v[112:127], a[196:199], a[32:35], v[112:127]
  v_bfi_b32 v145, s35, v57, v145
  v_bfi_b32 v146, s35, v58, v146
  v_bfi_b32 v147, s35, v59, v147
  s_cmp_eq_u32 s48, s51
  s_cbranch_scc1 L_nosend0
  buffer_store_dwordx4 v[128:131], v1, s[44:47], s34 offen offset:0 sc1
  buffer_store_dwordx4 v[144:147], v1, s[44:47], s34 offen offset:1024 sc1
L_nosend0:
  v_mfma_f32_32x32x16_bf16 v[112:127], a[204:207], a[36:39], v[112:127]
  v_mfma_f32_32x32x16_bf16 v[112:127], a[212:215], a[40:43], v[112:127]
  ds_write_b128 v176, v[96:99] offset:32768
  v_mfma_f32_32x32x16_bf16 v[112:127], a[220:223], a[44:47], v[112:127]
  ds_write_b128 v177, v[100:103] offset:32768
  v_mfma_f32_32x32x16_bf16 v[112:127], a[228:231], a[48:51], v[112:127]
  v_mfma_f32_32x32x16_bf16 v[112:127], a[236:239], a[52:55], v[112:127]
  ds_write_b128 v178, v[104:107] offset:32768
  v_mfma_f32_32x32x16_bf16 v[112:127], a[244:247], a[56:59], v[112:127]
  ds_write_b128 v179, v[108:111] offset:32768
  v_mfma_f32_32x32x16_bf16 v[112:127], a[252:255], a[60:63], v[112:127]
  s_nop 11
  ds_write_b128 v180, v[112:115] offset:32768
  ds_write_b128 v181, v[116:119] offset:32768
  ds_write_b128 v182, v[120:123] offset:32768
  ds_write_b128 v183, v[124:127] offset:32768
  s_waitcnt lgkmcnt(0)
  s_barrier
  ds_read_b128 v[128:131], v184 offset:32768
  ds_read_b128 v[132:135], v184 offset:40960
  ds_read_b128 v[136:139], v184 offset:49152
  ds_read_b128 v[140:143], v184 offset:57344
  ds_read_b128 v[144:147], v185 offset:33792
  ds_read_b128 v[148:151], v185 offset:41984
  ds_read_b128 v[152:155], v185 offset:50176
  ds_read_b128 v[156:159], v185 offset:58368
  s_cmp_lg_u32 s57, 1
  s_cbranch_scc1 L_noown1
  ds_read_b128 v[160:163], v186 offset:32768
  ds_read_b128 v[164:167], v186 offset:40960
  ds_read_b128 v[168:171], v186 offset:49152
  ds_read_b128 v[172:175], v186 offset:57344
L_noown1:
  s_waitcnt lgkmcnt(6)
  v_add_f32 v128, v128, v132
  v_add_f32 v129, v129, v133
  v_add_f32 v130, v130, v134
  v_add_f32 v131, v131, v135
  s_waitcnt lgkmcnt(4)
  v_add_f32 v136, v136, v140
  v_add_f32 v137, v137, v141
  v_add_f32 v138, v138, v142
  v_add_f32 v139, v139, v143
  v_add_f32 v128, v128, v136
  v_add_f32 v129, v129, v137
  v_add_f32 v130, v130, v138
  v_add_f32 v131, v131, v139
  v_bfi_b32 v128, s35, v60, v128
  v_bfi_b32 v129, s35, v61, v129
  v_bfi_b32 v130, s35, v62, v130
  v_bfi_b32 v131, s35, v63, v131
  s_waitcnt lgkmcnt(2)
  v_add_f32 v144, v144, v148
  v_add_f32 v145, v145, v149
  v_add_f32 v146, v146, v150
  v_add_f32 v147, v147, v151
  s_waitcnt lgkmcnt(0)
  v_add_f32 v152, v152, v156
  v_add_f32 v153, v153, v157
  v_add_f32 v154, v154, v158
  v_add_f32 v155, v155, v159
  v_add_f32 v144, v144, v152
  v_add_f32 v145, v145, v153
  v_add_f32 v146, v146, v154
  v_add_f32 v147, v147, v155
  v_bfi_b32 v144, s35, v60, v144
  v_bfi_b32 v145, s35, v61, v145
  v_bfi_b32 v146, s35, v62, v146
  v_bfi_b32 v147, s35, v63, v147
  s_cmp_eq_u32 s48, s51
  s_cbranch_scc1 L_nosend1
  buffer_store_dwordx4 v[128:131], v1, s[44:47], s33 offen offset:0 sc1
  buffer_store_dwordx4 v[144:147], v1, s[44:47], s33 offen offset:1024 sc1
L_nosend1:
  s_waitcnt lgkmcnt(0)
  v_pk_add_f32 v[160:161], v[160:161], v[164:165]
  v_pk_add_f32 v[168:169], v[168:169], v[172:173]
  v_pk_add_f32 v[162:163], v[162:163], v[166:167]
  v_pk_add_f32 v[170:171], v[170:171], v[174:175]
  v_pk_add_f32 v[160:161], v[160:161], v[168:169]
  v_pk_add_f32 v[162:163], v[162:163], v[170:171]
  s_waitcnt vmcnt(0)
L_p2:
  buffer_load_dwordx4 v[128:131], v1, s[44:47], s28 offen sc1
  buffer_load_dwordx4 v[132:135], v1, s[44:47], s29 offen sc1
  buffer_load_dwordx4 v[136:139], v1, s[44:47], s30 offen sc1
  v_mov_b32 v10, 0
  s_waitcnt vmcnt(2)
  v_perm_b32 v4, v129, v128, s32
  v_perm_b32 v5, v131, v130, s32
  v_bitop3_b32 v10, v4, v26, v10 bitop3:0xbe
  v_bitop3_b32 v10, v5, v27, v10 bitop3:0xbe
  v_and_b32 v128, 0xffffff00, v128
  v_and_b32 v129, 0xffffff00, v129
  v_and_b32 v130, 0xffffff00, v130
  v_and_b32 v131, 0xffffff00, v131
  s_waitcnt vmcnt(1)
  v_perm_b32 v4, v133, v132, s32
  v_perm_b32 v5, v135, v134, s32
  v_bitop3_b32 v10, v4, v26, v10 bitop3:0xbe
  v_bitop3_b32 v10, v5, v27, v10 bitop3:0xbe
  v_and_b32 v132, 0xffffff00, v132
  v_and_b32 v133, 0xffffff00, v133
  v_and_b32 v134, 0xffffff00, v134
  v_and_b32 v135, 0xffffff00, v135
  s_waitcnt vmcnt(0)
  v_perm_b32 v4, v137, v136, s32
  v_perm_b32 v5, v139, v138, s32
  v_bitop3_b32 v10, v4, v26, v10 bitop3:0xbe
  v_bitop3_b32 v10, v5, v27, v10 bitop3:0xbe
  v_and_b32 v136, 0xffffff00, v136
  v_and_b32 v137, 0xffffff00, v137
  v_and_b32 v138, 0xffffff00, v138
  v_and_b32 v139, 0xffffff00, v139
  v_cmp_ne_u32 vcc, 0, v10
  s_nop 0
  s_cbranch_vccz L_p2_ok
  s_sub_u32 s12, s12, 1
  s_cmp_lg_u32 s12, 0
  s_cbranch_scc1 L_p2
L_p2_ok:
  v_pk_add_f32 v[128:129], v[128:129], v[132:133]
  v_pk_add_f32 v[160:161], v[160:161], v[136:137]
  v_pk_add_f32 v[130:131], v[130:131], v[134:135]
  v_pk_add_f32 v[162:163], v[162:163], v[138:139]
  v_pk_add_f32 v[128:129], v[128:129], v[160:161]
  v_pk_add_f32 v[130:131], v[130:131], v[162:163]
  v_cvt_pk_bf16_f32 v40, v128, v129
  v_cvt_pk_bf16_f32 v41, v130, v131
  buffer_store_dwordx2 v[40:41], v187, s[40:43], s31 offen
  s_or_b32 s9, s51, s60
  s_or_b32 s9, s9, s58
  s_cmp_lg_u32 s9, 0
  s_cbranch_scc1 L_noepoch
  s_lshl_b32 s9, s52, 1
  s_add_u32 s9, s9, s57
  s_lshl_b32 s9, s9, 8
  s_add_u32 s9, s9, 10813440
  v_mov_b32 v4, s13
  v_mov_b32 v5, 0
  buffer_store_dword v4, v5, s[44:47], s9 offen
L_noepoch:
  s_endpgm
L_end:
L_fb:
  s_waitcnt vmcnt(0) lgkmcnt(0)
  v_and_b32 v4, 31, v0
  v_lshrrev_b32 v5, 5, v0
  v_lshlrev_b32 v5, 4, v5
  v_lshl_add_u32 v4, v4, 8, v5
  s_and_b32 s5, s64, 0xffffefff
  s_xor_b32 s4, s5, 0
  buffer_load_dwordx4 a[128:131], v4, s[24:27], s4 offen offset:0
  buffer_load_dwordx4 a[132:135], v4, s[24:27], s4 offen offset:32
  buffer_load_dwordx4 a[136:139], v4, s[24:27], s4 offen offset:64
  buffer_load_dwordx4 a[140:143], v4, s[24:27], s4 offen offset:96
  buffer_load_dwordx4 a[144:147], v4, s[24:27], s4 offen offset:128
  buffer_load_dwordx4 a[148:151], v4, s[24:27], s4 offen offset:160
  buffer_load_dwordx4 a[152:155], v4, s[24:27], s4 offen offset:192
  buffer_load_dwordx4 a[156:159], v4, s[24:27], s4 offen offset:224
  s_waitcnt vmcnt(7)
  v_mfma_f32_32x32x16_bf16 v[128:143], a[128:131], v[80:83], 0
  s_waitcnt vmcnt(6)
  v_mfma_f32_32x32x16_bf16 v[128:143], a[132:135], v[84:87], v[128:143]
  s_waitcnt vmcnt(5)
  v_mfma_f32_32x32x16_bf16 v[128:143], a[136:139], v[88:91], v[128:143]
  s_waitcnt vmcnt(4)
  v_mfma_f32_32x32x16_bf16 v[128:143], a[140:143], v[92:95], v[128:143]
  s_waitcnt vmcnt(3)
  v_mfma_f32_32x32x16_bf16 v[128:143], a[144:147], v[96:99], v[128:143]
  s_waitcnt vmcnt(2)
  v_mfma_f32_32x32x16_bf16 v[128:143], a[148:151], v[100:103], v[128:143]
  s_waitcnt vmcnt(1)
  v_mfma_f32_32x32x16_bf16 v[128:143], a[152:155], v[104:107], v[128:143]
  s_waitcnt vmcnt(0)
  v_mfma_f32_32x32x16_bf16 v[128:143], a[156:159], v[108:111], v[128:143]
  s_nop 7
  s_nop 7
  s_xor_b32 s4, s5, 8192
  buffer_load_dwordx4 a[128:131], v4, s[24:27], s4 offen offset:0
  buffer_load_dwordx4 a[132:135], v4, s[24:27], s4 offen offset:32
  buffer_load_dwordx4 a[136:139], v4, s[24:27], s4 offen offset:64
  buffer_load_dwordx4 a[140:143], v4, s[24:27], s4 offen offset:96
  buffer_load_dwordx4 a[144:147], v4, s[24:27], s4 offen offset:128
  buffer_load_dwordx4 a[148:151], v4, s[24:27], s4 offen offset:160
  buffer_load_dwordx4 a[152:155], v4, s[24:27], s4 offen offset:192
  buffer_load_dwordx4 a[156:159], v4, s[24:27], s4 offen offset:224
  s_waitcnt vmcnt(7)
  v_mfma_f32_32x32x16_bf16 v[144:159], a[128:131], v[80:83], 0
  s_waitcnt vmcnt(6)
  v_mfma_f32_32x32x16_bf16 v[144:159], a[132:135], v[84:87], v[144:159]
  s_waitcnt vmcnt(5)
  v_mfma_f32_32x32x16_bf16 v[144:159], a[136:139], v[88:91], v[144:159]
  s_waitcnt vmcnt(4)
  v_mfma_f32_32x32x16_bf16 v[144:159], a[140:143], v[92:95], v[144:159]
  s_waitcnt vmcnt(3)
  v_mfma_f32_32x32x16_bf16 v[144:159], a[144:147], v[96:99], v[144:159]
  s_waitcnt vmcnt(2)
  v_mfma_f32_32x32x16_bf16 v[144:159], a[148:151], v[100:103], v[144:159]
  s_waitcnt vmcnt(1)
  v_mfma_f32_32x32x16_bf16 v[144:159], a[152:155], v[104:107], v[144:159]
  s_waitcnt vmcnt(0)
  v_mfma_f32_32x32x16_bf16 v[144:159], a[156:159], v[108:111], v[144:159]
  s_nop 7
  s_nop 7
  s_xor_b32 s4, s5, 16384
  buffer_load_dwordx4 a[128:131], v4, s[24:27], s4 offen offset:0
  buffer_load_dwordx4 a[132:135], v4, s[24:27], s4 offen offset:32
  buffer_load_dwordx4 a[136:139], v4, s[24:27], s4 offen offset:64
  buffer_load_dwordx4 a[140:143], v4, s[24:27], s4 offen offset:96
  buffer_load_dwordx4 a[144:147], v4, s[24:27], s4 offen offset:128
  buffer_load_dwordx4 a[148:151], v4, s[24:27], s4 offen offset:160
  buffer_load_dwordx4 a[152:155], v4, s[24:27], s4 offen offset:192
  buffer_load_dwordx4 a[156:159], v4, s[24:27], s4 offen offset:224
  s_waitcnt vmcnt(7)
  v_mfma_f32_32x32x16_bf16 v[160:175], a[128:131], v[80:83], 0
  s_waitcnt vmcnt(6)
  v_mfma_f32_32x32x16_bf16 v[160:175], a[132:135], v[84:87], v[160:175]
  s_waitcnt vmcnt(5)
  v_mfma_f32_32x32x16_bf16 v[160:175], a[136:139], v[88:91], v[160:175]
  s_waitcnt vmcnt(4)
  v_mfma_f32_32x32x16_bf16 v[160:175], a[140:143], v[92:95], v[160:175]
  s_waitcnt vmcnt(3)
  v_mfma_f32_32x32x16_bf16 v[160:175], a[144:147], v[96:99], v[160:175]
  s_waitcnt vmcnt(2)
  v_mfma_f32_32x32x16_bf16 v[160:175], a[148:151], v[100:103], v[160:175]
  s_waitcnt vmcnt(1)
  v_mfma_f32_32x32x16_bf16 v[160:175], a[152:155], v[104:107], v[160:175]
  s_waitcnt vmcnt(0)
  v_mfma_f32_32x32x16_bf16 v[160:175], a[156:159], v[108:111], v[160:175]
  s_nop 7
  s_nop 7
  s_xor_b32 s4, s5, 24576
  buffer_load_dwordx4 a[128:131], v4, s[24:27], s4 offen offset:0
  buffer_load_dwordx4 a[132:135], v4, s[24:27], s4 offen offset:32
  buffer_load_dwordx4 a[136:139], v4, s[24:27], s4 offen offset:64
  buffer_load_dwordx4 a[140:143], v4, s[24:27], s4 offen offset:96
  buffer_load_dwordx4 a[144:147], v4, s[24:27], s4 offen offset:128
  buffer_load_dwordx4 a[148:151], v4, s[24:27], s4 offen offset:160
  buffer_load_dwordx4 a[152:155], v4, s[24:27], s4 offen offset:192
  buffer_load_dwordx4 a[156:159], v4, s[24:27], s4 offen offset:224
  s_waitcnt vmcnt(7)
  v_mfma_f32_32x32x16_bf16 v[176:191], a[128:131], v[80:83], 0
  s_waitcnt vmcnt(6)
  v_mfma_f32_32x32x16_bf16 v[176:191], a[132:135], v[84:87], v[176:191]
  s_waitcnt vmcnt(5)
  v_mfma_f32_32x32x16_bf16 v[176:191], a[136:139], v[88:91], v[176:191]
  s_waitcnt vmcnt(4)
  v_mfma_f32_32x32x16_bf16 v[176:191], a[140:143], v[92:95], v[176:191]
  s_waitcnt vmcnt(3)
  v_mfma_f32_32x32x16_bf16 v[176:191], a[144:147], v[96:99], v[176:191]
  s_waitcnt vmcnt(2)
  v_mfma_f32_32x32x16_bf16 v[176:191], a[148:151], v[100:103], v[176:191]
  s_waitcnt vmcnt(1)
  v_mfma_f32_32x32x16_bf16 v[176:191], a[152:155], v[104:107], v[176:191]
  s_waitcnt vmcnt(0)
  v_mfma_f32_32x32x16_bf16 v[176:191], a[156:159], v[108:111], v[176:191]
  s_nop 7
  s_nop 7
  s_xor_b32 s4, s5, 32768
  buffer_load_dwordx4 a[128:131], v4, s[24:27], s4 offen offset:0
  buffer_load_dwordx4 a[132:135], v4, s[24:27], s4 offen offset:32
  buffer_load_dwordx4 a[136:139], v4, s[24:27], s4 offen offset:64
  buffer_load_dwordx4 a[140:143], v4, s[24:27], s4 offen offset:96
  buffer_load_dwordx4 a[144:147], v4, s[24:27], s4 offen offset:128
  buffer_load_dwordx4 a[148:151], v4, s[24:27], s4 offen offset:160
  buffer_load_dwordx4 a[152:155], v4, s[24:27], s4 offen offset:192
  buffer_load_dwordx4 a[156:159], v4, s[24:27], s4 offen offset:224
  s_waitcnt vmcnt(7)
  v_mfma_f32_32x32x16_bf16 v[192:207], a[128:131], v[80:83], 0
  s_waitcnt vmcnt(6)
  v_mfma_f32_32x32x16_bf16 v[192:207], a[132:135], v[84:87], v[192:207]
  s_waitcnt vmcnt(5)
  v_mfma_f32_32x32x16_bf16 v[192:207], a[136:139], v[88:91], v[192:207]
  s_waitcnt vmcnt(4)
  v_mfma_f32_32x32x16_bf16 v[192:207], a[140:143], v[92:95], v[192:207]
  s_waitcnt vmcnt(3)
  v_mfma_f32_32x32x16_bf16 v[192:207], a[144:147], v[96:99], v[192:207]
  s_waitcnt vmcnt(2)
  v_mfma_f32_32x32x16_bf16 v[192:207], a[148:151], v[100:103], v[192:207]
  s_waitcnt vmcnt(1)
  v_mfma_f32_32x32x16_bf16 v[192:207], a[152:155], v[104:107], v[192:207]
  s_waitcnt vmcnt(0)
  v_mfma_f32_32x32x16_bf16 v[192:207], a[156:159], v[108:111], v[192:207]
  s_nop 7
  s_nop 7
  s_xor_b32 s4, s5, 40960
  buffer_load_dwordx4 a[128:131], v4, s[24:27], s4 offen offset:0
  buffer_load_dwordx4 a[132:135], v4, s[24:27], s4 offen offset:32
  buffer_load_dwordx4 a[136:139], v4, s[24:27], s4 offen offset:64
  buffer_load_dwordx4 a[140:143], v4, s[24:27], s4 offen offset:96
  buffer_load_dwordx4 a[144:147], v4, s[24:27], s4 offen offset:128
  buffer_load_dwordx4 a[148:151], v4, s[24:27], s4 offen offset:160
  buffer_load_dwordx4 a[152:155], v4, s[24:27], s4 offen offset:192
  buffer_load_dwordx4 a[156:159], v4, s[24:27], s4 offen offset:224
  s_waitcnt vmcnt(7)
  v_mfma_f32_32x32x16_bf16 v[208:223], a[128:131], v[80:83], 0
  s_waitcnt vmcnt(6)
  v_mfma_f32_32x32x16_bf16 v[208:223], a[132:135], v[84:87], v[208:223]
  s_waitcnt vmcnt(5)
  v_mfma_f32_32x32x16_bf16 v[208:223], a[136:139], v[88:91], v[208:223]
  s_waitcnt vmcnt(4)
  v_mfma_f32_32x32x16_bf16 v[208:223], a[140:143], v[92:95], v[208:223]
  s_waitcnt vmcnt(3)
  v_mfma_f32_32x32x16_bf16 v[208:223], a[144:147], v[96:99], v[208:223]
  s_waitcnt vmcnt(2)
  v_mfma_f32_32x32x16_bf16 v[208:223], a[148:151], v[100:103], v[208:223]
  s_waitcnt vmcnt(1)
  v_mfma_f32_32x32x16_bf16 v[208:223], a[152:155], v[104:107], v[208:223]
  s_waitcnt vmcnt(0)
  v_mfma_f32_32x32x16_bf16 v[208:223], a[156:159], v[108:111], v[208:223]
  s_nop 7
  s_nop 7
  s_xor_b32 s4, s5, 49152
  buffer_load_dwordx4 a[128:131], v4, s[24:27], s4 offen offset:0
  buffer_load_dwordx4 a[132:135], v4, s[24:27], s4 offen offset:32
  buffer_load_dwordx4 a[136:139], v4, s[24:27], s4 offen offset:64
  buffer_load_dwordx4 a[140:143], v4, s[24:27], s4 offen offset:96
  buffer_load_dwordx4 a[144:147], v4, s[24:27], s4 offen offset:128
  buffer_load_dwordx4 a[148:151], v4, s[24:27], s4 offen offset:160
  buffer_load_dwordx4 a[152:155], v4, s[24:27], s4 offen offset:192
  buffer_load_dwordx4 a[156:159], v4, s[24:27], s4 offen offset:224
  s_waitcnt vmcnt(7)
  v_mfma_f32_32x32x16_bf16 v[224:239], a[128:131], v[80:83], 0
  s_waitcnt vmcnt(6)
  v_mfma_f32_32x32x16_bf16 v[224:239], a[132:135], v[84:87], v[224:239]
  s_waitcnt vmcnt(5)
  v_mfma_f32_32x32x16_bf16 v[224:239], a[136:139], v[88:91], v[224:239]
  s_waitcnt vmcnt(4)
  v_mfma_f32_32x32x16_bf16 v[224:239], a[140:143], v[92:95], v[224:239]
  s_waitcnt vmcnt(3)
  v_mfma_f32_32x32x16_bf16 v[224:239], a[144:147], v[96:99], v[224:239]
  s_waitcnt vmcnt(2)
  v_mfma_f32_32x32x16_bf16 v[224:239], a[148:151], v[100:103], v[224:239]
  s_waitcnt vmcnt(1)
  v_mfma_f32_32x32x16_bf16 v[224:239], a[152:155], v[104:107], v[224:239]
  s_waitcnt vmcnt(0)
  v_mfma_f32_32x32x16_bf16 v[224:239], a[156:159], v[108:111], v[224:239]
  s_nop 7
  s_nop 7
  s_xor_b32 s4, s5, 57344
  buffer_load_dwordx4 a[128:131], v4, s[24:27], s4 offen offset:0
  buffer_load_dwordx4 a[132:135], v4, s[24:27], s4 offen offset:32
  buffer_load_dwordx4 a[136:139], v4, s[24:27], s4 offen offset:64
  buffer_load_dwordx4 a[140:143], v4, s[24:27], s4 offen offset:96
  buffer_load_dwordx4 a[144:147], v4, s[24:27], s4 offen offset:128
  buffer_load_dwordx4 a[148:151], v4, s[24:27], s4 offen offset:160
  buffer_load_dwordx4 a[152:155], v4, s[24:27], s4 offen offset:192
  buffer_load_dwordx4 a[156:159], v4, s[24:27], s4 offen offset:224
  s_waitcnt vmcnt(7)
  v_mfma_f32_32x32x16_bf16 v[240:255], a[128:131], v[80:83], 0
  s_waitcnt vmcnt(6)
  v_mfma_f32_32x32x16_bf16 v[240:255], a[132:135], v[84:87], v[240:255]
  s_waitcnt vmcnt(5)
  v_mfma_f32_32x32x16_bf16 v[240:255], a[136:139], v[88:91], v[240:255]
  s_waitcnt vmcnt(4)
  v_mfma_f32_32x32x16_bf16 v[240:255], a[140:143], v[92:95], v[240:255]
  s_waitcnt vmcnt(3)
  v_mfma_f32_32x32x16_bf16 v[240:255], a[144:147], v[96:99], v[240:255]
  s_waitcnt vmcnt(2)
  v_mfma_f32_32x32x16_bf16 v[240:255], a[148:151], v[100:103], v[240:255]
  s_waitcnt vmcnt(1)
  v_mfma_f32_32x32x16_bf16 v[240:255], a[152:155], v[104:107], v[240:255]
  s_waitcnt vmcnt(0)
  v_mfma_f32_32x32x16_bf16 v[240:255], a[156:159], v[108:111], v[240:255]
  s_nop 7
  s_nop 7
  v_max3_f32 v39, v128, v129, v130
  v_max3_f32 v39, v39, v131, v132
  v_max3_f32 v39, v39, v133, v134
  v_max3_f32 v39, v39, v135, v136
  v_max3_f32 v39, v39, v137, v138
  v_max3_f32 v39, v39, v139, v140
  v_max3_f32 v39, v39, v141, v142
  v_max_f32 v39, v39, v143
  v_mov_b32 v37, v39
  v_max3_f32 v39, v144, v145, v146
  v_max3_f32 v39, v39, v147, v148
  v_max3_f32 v39, v39, v149, v150
  v_max3_f32 v39, v39, v151, v152
  v_max3_f32 v39, v39, v153, v154
  v_max3_f32 v39, v39, v155, v156
  v_max3_f32 v39, v39, v157, v158
  v_max_f32 v39, v39, v159
  v_max_f32 v37, v37, v39
  v_max3_f32 v39, v160, v161, v162
  v_max3_f32 v39, v39, v163, v164
  v_max3_f32 v39, v39, v165, v166
  v_max3_f32 v39, v39, v167, v168
  v_max3_f32 v39, v39, v169, v170
  v_max3_f32 v39, v39, v171, v172
  v_max3_f32 v39, v39, v173, v174
  v_max_f32 v39, v39, v175
  v_max_f32 v37, v37, v39
  v_max3_f32 v39, v176, v177, v178
  v_max3_f32 v39, v39, v179, v180
  v_max3_f32 v39, v39, v181, v182
  v_max3_f32 v39, v39, v183, v184
  v_max3_f32 v39, v39, v185, v186
  v_max3_f32 v39, v39, v187, v188
  v_max3_f32 v39, v39, v189, v190
  v_max_f32 v39, v39, v191
  v_max_f32 v37, v37, v39
  v_max3_f32 v39, v192, v193, v194
  v_max3_f32 v39, v39, v195, v196
  v_max3_f32 v39, v39, v197, v198
  v_max3_f32 v39, v39, v199, v200
  v_max3_f32 v39, v39, v201, v202
  v_max3_f32 v39, v39, v203, v204
  v_max3_f32 v39, v39, v205, v206
  v_max_f32 v39, v39, v207
  v_max_f32 v37, v37, v39
  v_max3_f32 v39, v208, v209, v210
  v_max3_f32 v39, v39, v211, v212
  v_max3_f32 v39, v39, v213, v214
  v_max3_f32 v39, v39, v215, v216
  v_max3_f32 v39, v39, v217, v218
  v_max3_f32 v39, v39, v219, v220
  v_max3_f32 v39, v39, v221, v222
  v_max_f32 v39, v39, v223
  v_max_f32 v37, v37, v39
  v_max3_f32 v39, v224, v225, v226
  v_max3_f32 v39, v39, v227, v228
  v_max3_f32 v39, v39, v229, v230
  v_max3_f32 v39, v39, v231, v232
  v_max3_f32 v39, v39, v233, v234
  v_max3_f32 v39, v39, v235, v236
  v_max3_f32 v39, v39, v237, v238
  v_max_f32 v39, v39, v239
  v_max_f32 v37, v37, v39
  v_max3_f32 v39, v240, v241, v242
  v_max3_f32 v39, v39, v243, v244
  v_max3_f32 v39, v39, v245, v246
  v_max3_f32 v39, v39, v247, v248
  v_max3_f32 v39, v39, v249, v250
  v_max3_f32 v39, v39, v251, v252
  v_max3_f32 v39, v39, v253, v254
  v_max_f32 v39, v39, v255
  v_max_f32 v37, v37, v39
  v_mov_b32 v39, v37
  s_nop 1
  v_permlane32_swap_b32 v37, v39
  v_max_f32 v37, v37, v39
  v_sub_f32 v128, v128, v37
  v_sub_f32 v129, v129, v37
  v_sub_f32 v130, v130, v37
  v_sub_f32 v131, v131, v37
  v_sub_f32 v132, v132, v37
  v_sub_f32 v133, v133, v37
  v_sub_f32 v134, v134, v37
  v_sub_f32 v135, v135, v37
  v_sub_f32 v136, v136, v37
  v_sub_f32 v137, v137, v37
  v_sub_f32 v138, v138, v37
  v_sub_f32 v139, v139, v37
  v_sub_f32 v140, v140, v37
  v_sub_f32 v141, v141, v37
  v_sub_f32 v142, v142, v37
  v_sub_f32 v143, v143, v37
  v_sub_f32 v144, v144, v37
  v_sub_f32 v145, v145, v37
  v_sub_f32 v146, v146, v37
  v_sub_f32 v147, v147, v37
  v_sub_f32 v148, v148, v37
  v_sub_f32 v149, v149, v37
  v_sub_f32 v150, v150, v37
  v_sub_f32 v151, v151, v37
  v_sub_f32 v152, v152, v37
  v_sub_f32 v153, v153, v37
  v_sub_f32 v154, v154, v37
  v_sub_f32 v155, v155, v37
  v_sub_f32 v156, v156, v37
  v_sub_f32 v157, v157, v37
  v_sub_f32 v158, v158, v37
  v_sub_f32 v159, v159, v37
  v_sub_f32 v160, v160, v37
  v_sub_f32 v161, v161, v37
  v_sub_f32 v162, v162, v37
  v_sub_f32 v163, v163, v37
  v_sub_f32 v164, v164, v37
  v_sub_f32 v165, v165, v37
  v_sub_f32 v166, v166, v37
  v_sub_f32 v167, v167, v37
  v_sub_f32 v168, v168, v37
  v_sub_f32 v169, v169, v37
  v_sub_f32 v170, v170, v37
  v_sub_f32 v171, v171, v37
  v_sub_f32 v172, v172, v37
  v_sub_f32 v173, v173, v37
  v_sub_f32 v174, v174, v37
  v_sub_f32 v175, v175, v37
  v_sub_f32 v176, v176, v37
  v_sub_f32 v177, v177, v37
  v_sub_f32 v178, v178, v37
  v_sub_f32 v179, v179, v37
  v_sub_f32 v180, v180, v37
  v_sub_f32 v181, v181, v37
  v_sub_f32 v182, v182, v37
  v_sub_f32 v183, v183, v37
  v_sub_f32 v184, v184, v37
  v_sub_f32 v185, v185, v37
  v_sub_f32 v186, v186, v37
  v_sub_f32 v187, v187, v37
  v_sub_f32 v188, v188, v37
  v_sub_f32 v189, v189, v37
  v_sub_f32 v190, v190, v37
  v_sub_f32 v191, v191, v37
  v_sub_f32 v192, v192, v37
  v_sub_f32 v193, v193, v37
  v_sub_f32 v194, v194, v37
  v_sub_f32 v195, v195, v37
  v_sub_f32 v196, v196, v37
  v_sub_f32 v197, v197, v37
  v_sub_f32 v198, v198, v37
  v_sub_f32 v199, v199, v37
  v_sub_f32 v200, v200, v37
  v_sub_f32 v201, v201, v37
  v_sub_f32 v202, v202, v37
  v_sub_f32 v203, v203, v37
  v_sub_f32 v204, v204, v37
  v_sub_f32 v205, v205, v37
  v_sub_f32 v206, v206, v37
  v_sub_f32 v207, v207, v37
  v_sub_f32 v208, v208, v37
  v_sub_f32 v209, v209, v37
  v_sub_f32 v210, v210, v37
  v_sub_f32 v211, v211, v37
  v_sub_f32 v212, v212, v37
  v_sub_f32 v213, v213, v37
  v_sub_f32 v214, v214, v37
  v_sub_f32 v215, v215, v37
  v_sub_f32 v216, v216, v37
  v_sub_f32 v217, v217, v37
  v_sub_f32 v218, v218, v37
  v_sub_f32 v219, v219, v37
  v_sub_f32 v220, v220, v37
  v_sub_f32 v221, v221, v37
  v_sub_f32 v222, v222, v37
  v_sub_f32 v223, v223, v37
  v_sub_f32 v224, v224, v37
  v_sub_f32 v225, v225, v37
  v_sub_f32 v226, v226, v37
  v_sub_f32 v227, v227, v37
  v_sub_f32 v228, v228, v37
  v_sub_f32 v229, v229, v37
  v_sub_f32 v230, v230, v37
  v_sub_f32 v231, v231, v37
  v_sub_f32 v232, v232, v37
  v_sub_f32 v233, v233, v37
  v_sub_f32 v234, v234, v37
  v_sub_f32 v235, v235, v37
  v_sub_f32 v236, v236, v37
  v_sub_f32 v237, v237, v37
  v_sub_f32 v238, v238, v37
  v_sub_f32 v239, v239, v37
  v_sub_f32 v240, v240, v37
  v_sub_f32 v241, v241, v37
  v_sub_f32 v242, v242, v37
  v_sub_f32 v243, v243, v37
  v_sub_f32 v244, v244, v37
  v_sub_f32 v245, v245, v37
  v_sub_f32 v246, v246, v37
  v_sub_f32 v247, v247, v37
  v_sub_f32 v248, v248, v37
  v_sub_f32 v249, v249, v37
  v_sub_f32 v250, v250, v37
  v_sub_f32 v251, v251, v37
  v_sub_f32 v252, v252, v37
  v_sub_f32 v253, v253, v37
  v_sub_f32 v254, v254, v37
  v_sub_f32 v255, v255, v37
  v_exp_f32 v128, v128
  v_exp_f32 v129, v129
  v_exp_f32 v130, v130
  v_exp_f32 v131, v131
  v_exp_f32 v132, v132
  v_exp_f32 v133, v133
  v_exp_f32 v134, v134
  v_exp_f32 v135, v135
  v_mov_b32 v38, v128
  v_mov_b32 v56, v129
  v_add_f32 v38, v38, v130
  v_add_f32 v56, v56, v131
  v_add_f32 v38, v38, v132
  v_add_f32 v56, v56, v133
  v_add_f32 v38, v38, v134
  v_add_f32 v56, v56, v135
  v_exp_f32 v136, v136
  v_exp_f32 v137, v137
  v_exp_f32 v138, v138
  v_exp_f32 v139, v139
  v_exp_f32 v140, v140
  v_exp_f32 v141, v141
  v_exp_f32 v142, v142
  v_exp_f32 v143, v143
  v_add_f32 v38, v38, v136
  v_add_f32 v56, v56, v137
  v_add_f32 v38, v38, v138
  v_add_f32 v56, v56, v139
  v_add_f32 v38, v38, v140
  v_add_f32 v56, v56, v141
  v_add_f32 v38, v38, v142
  v_add_f32 v56, v56, v143
  v_exp_f32 v144, v144
  v_exp_f32 v145, v145
  v_exp_f32 v146, v146
  v_exp_f32 v147, v147
  v_exp_f32 v148, v148
  v_exp_f32 v149, v149
  v_exp_f32 v150, v150
  v_exp_f32 v151, v151
  v_add_f32 v38, v38, v144
  v_add_f32 v56, v56, v145
  v_add_f32 v38, v38, v146
  v_add_f32 v56, v56, v147
  v_add_f32 v38, v38, v148
  v_add_f32 v56, v56, v149
  v_add_f32 v38, v38, v150
  v_add_f32 v56, v56, v151
  v_exp_f32 v152, v152
  v_exp_f32 v153, v153
  v_exp_f32 v154, v154
  v_exp_f32 v155, v155
  v_exp_f32 v156, v156
  v_exp_f32 v157, v157
  v_exp_f32 v158, v158
  v_exp_f32 v159, v159
  v_add_f32 v38, v38, v152
  v_add_f32 v56, v56, v153
  v_add_f32 v38, v38, v154
  v_add_f32 v56, v56, v155
  v_add_f32 v38, v38, v156
  v_add_f32 v56, v56, v157
  v_add_f32 v38, v38, v158
  v_add_f32 v56, v56, v159
  v_exp_f32 v160, v160
  v_exp_f32 v161, v161
  v_exp_f32 v162, v162
  v_exp_f32 v163, v163
  v_exp_f32 v164, v164
  v_exp_f32 v165, v165
  v_exp_f32 v166, v166
  v_exp_f32 v167, v167
  v_add_f32 v38, v38, v160
  v_add_f32 v56, v56, v161
  v_add_f32 v38, v38, v162
  v_add_f32 v56, v56, v163
  v_add_f32 v38, v38, v164
  v_add_f32 v56, v56, v165
  v_add_f32 v38, v38, v166
  v_add_f32 v56, v56, v167
  v_exp_f32 v168, v168
  v_exp_f32 v169, v169
  v_exp_f32 v170, v170
  v_exp_f32 v171, v171
  v_exp_f32 v172, v172
  v_exp_f32 v173, v173
  v_exp_f32 v174, v174
  v_exp_f32 v175, v175
  v_add_f32 v38, v38, v168
  v_add_f32 v56, v56, v169
  v_add_f32 v38, v38, v170
  v_add_f32 v56, v56, v171
  v_add_f32 v38, v38, v172
  v_add_f32 v56, v56, v173
  v_add_f32 v38, v38, v174
  v_add_f32 v56, v56, v175
  v_exp_f32 v176, v176
  v_exp_f32 v177, v177
  v_exp_f32 v178, v178
  v_exp_f32 v179, v179
  v_exp_f32 v180, v180
  v_exp_f32 v181, v181
  v_exp_f32 v182, v182
  v_exp_f32 v183, v183
  v_add_f32 v38, v38, v176
  v_add_f32 v56, v56, v177
  v_add_f32 v38, v38, v178
  v_add_f32 v56, v56, v179
  v_add_f32 v38, v38, v180
  v_add_f32 v56, v56, v181
  v_add_f32 v38, v38, v182
  v_add_f32 v56, v56, v183
  v_exp_f32 v184, v184
  v_exp_f32 v185, v185
  v_exp_f32 v186, v186
  v_exp_f32 v187, v187
  v_exp_f32 v188, v188
  v_exp_f32 v189, v189
  v_exp_f32 v190, v190
  v_exp_f32 v191, v191
  v_add_f32 v38, v38, v184
  v_add_f32 v56, v56, v185
  v_add_f32 v38, v38, v186
  v_add_f32 v56, v56, v187
  v_add_f32 v38, v38, v188
  v_add_f32 v56, v56, v189
  v_add_f32 v38, v38, v190
  v_add_f32 v56, v56, v191
  v_exp_f32 v192, v192
  v_exp_f32 v193, v193
  v_exp_f32 v194, v194
  v_exp_f32 v195, v195
  v_exp_f32 v196, v196
  v_exp_f32 v197, v197
  v_exp_f32 v198, v198
  v_exp_f32 v199, v199
  v_add_f32 v38, v38, v192
  v_add_f32 v56, v56, v193
  v_add_f32 v38, v38, v194
  v_add_f32 v56, v56, v195
  v_add_f32 v38, v38, v196
  v_add_f32 v56, v56, v197
  v_add_f32 v38, v38, v198
  v_add_f32 v56, v56, v199
  v_exp_f32 v200, v200
  v_exp_f32 v201, v201
  v_exp_f32 v202, v202
  v_exp_f32 v203, v203
  v_exp_f32 v204, v204
  v_exp_f32 v205, v205
  v_exp_f32 v206, v206
  v_exp_f32 v207, v207
  v_add_f32 v38, v38, v200
  v_add_f32 v56, v56, v201
  v_add_f32 v38, v38, v202
  v_add_f32 v56, v56, v203
  v_add_f32 v38, v38, v204
  v_add_f32 v56, v56, v205
  v_add_f32 v38, v38, v206
  v_add_f32 v56, v56, v207
  v_exp_f32 v208, v208
  v_exp_f32 v209, v209
  v_exp_f32 v210, v210
  v_exp_f32 v211, v211
  v_exp_f32 v212, v212
  v_exp_f32 v213, v213
  v_exp_f32 v214, v214
  v_exp_f32 v215, v215
  v_add_f32 v38, v38, v208
  v_add_f32 v56, v56, v209
  v_add_f32 v38, v38, v210
  v_add_f32 v56, v56, v211
  v_add_f32 v38, v38, v212
  v_add_f32 v56, v56, v213
  v_add_f32 v38, v38, v214
  v_add_f32 v56, v56, v215
  v_exp_f32 v216, v216
  v_exp_f32 v217, v217
  v_exp_f32 v218, v218
  v_exp_f32 v219, v219
  v_exp_f32 v220, v220
  v_exp_f32 v221, v221
  v_exp_f32 v222, v222
  v_exp_f32 v223, v223
  v_add_f32 v38, v38, v216
  v_add_f32 v56, v56, v217
  v_add_f32 v38, v38, v218
  v_add_f32 v56, v56, v219
  v_add_f32 v38, v38, v220
  v_add_f32 v56, v56, v221
  v_add_f32 v38, v38, v222
  v_add_f32 v56, v56, v223
  v_exp_f32 v224, v224
  v_exp_f32 v225, v225
  v_exp_f32 v226, v226
  v_exp_f32 v227, v227
  v_exp_f32 v228, v228
  v_exp_f32 v229, v229
  v_exp_f32 v230, v230
  v_exp_f32 v231, v231
  v_add_f32 v38, v38, v224
  v_add_f32 v56, v56, v225
  v_add_f32 v38, v38, v226
  v_add_f32 v56, v56, v227
  v_add_f32 v38, v38, v228
  v_add_f32 v56, v56, v229
  v_add_f32 v38, v38, v230
  v_add_f32 v56, v56, v231
  v_exp_f32 v232, v232
  v_exp_f32 v233, v233
  v_exp_f32 v234, v234
  v_exp_f32 v235, v235
  v_exp_f32 v236, v236
  v_exp_f32 v237, v237
  v_exp_f32 v238, v238
  v_exp_f32 v239, v239
  v_add_f32 v38, v38, v232
  v_add_f32 v56, v56, v233
  v_add_f32 v38, v38, v234
  v_add_f32 v56, v56, v235
  v_add_f32 v38, v38, v236
  v_add_f32 v56, v56, v237
  v_add_f32 v38, v38, v238
  v_add_f32 v56, v56, v239
  v_cvt_pk_bf16_f32 v128, v128, v129
  v_cvt_pk_bf16_f32 v129, v130, v131
  v_cvt_pk_bf16_f32 v130, v132, v133
  v_cvt_pk_bf16_f32 v131, v134, v135
  s_nop 1
  s_branch L_fb_ret
.section .rodata,"a"
.p2align 6
.amdhsa_kernel standalone__gqa_block_cached__near_ridge_kernel
  .amdhsa_next_free_vgpr 512
  .amdhsa_next_free_sgpr 102
  .amdhsa_accum_offset 256
  .amdhsa_group_segment_fixed_size 0
  .amdhsa_kernarg_size 64
  .amdhsa_user_sgpr_count 2
  .amdhsa_user_sgpr_kernarg_segment_ptr 1
  .amdhsa_system_sgpr_workgroup_id_x 1
  .amdhsa_float_denorm_mode_32 3
.end_amdhsa_kernel
```
